```python
import torch

def _softmax(x, axis=-1):
    return torch.softmax(x, dim=axis)
def _gelu(x):
    return torch.nn.functional.gelu(x, approximate="tanh")
def _silu(x):
    return torch.nn.functional.silu(x)
def _sigmoid(x):
    return torch.sigmoid(x)
def _layernorm(x, axis=-1, eps=1e-5):
    m = x.mean(dim=axis, keepdim=True)
    v = x.var(dim=axis, keepdim=True, unbiased=False)
    return (x - m) / torch.sqrt(v + eps)
def _scatter_add(tgt, idx, src, axis=0):
    return tgt.clone().index_add_(axis, idx, src)
def _segment_sum(src, seg, n):
    out = torch.zeros((n,) + src.shape[1:], dtype=src.dtype)
    return out.index_add_(0, seg, src)
def _pad(x, pw):
    flat = tuple(v for pair in reversed(pw) for v in pair)
    return torch.nn.functional.pad(x, flat)

kernel_name = 'recurrent_scan__ssm_conv_s4__mixer_token_mlp__prompt'

def setup_inputs():

    _w = (lambda a: (lambda t: t.to(torch.bfloat16) if t.is_floating_point() else t)(torch.as_tensor(a)))
    def _A_setup():
        B, L, D, N = 1, 2048, 512, 128
        A_re = -(lambda _x: torch.exp(torch.as_tensor(_x)))((lambda *s: torch.randn(*s, dtype=torch.bfloat16) * 3.2)(D, N))
        A_im = torch.pi * (lambda *s: torch.randn(*s, dtype=torch.bfloat16) * 0.2)(D, N)
        B_re = (lambda *s: torch.randn(*s, dtype=torch.bfloat16) * 0.2)(D, N)
        B_im = (lambda *s: torch.randn(*s, dtype=torch.bfloat16) * 0.2)(D, N)
        C_re = (lambda *s: torch.randn(*s, dtype=torch.bfloat16) * 0.2)(D, N)
        C_im = (lambda *s: torch.randn(*s, dtype=torch.bfloat16) * 0.2)(D, N)
        log_dt = (lambda *s: torch.randn(*s, dtype=torch.bfloat16) * 0.2)(D) * 0.5 - 4.0
        Dskip = (lambda *s: torch.randn(*s, dtype=torch.bfloat16) * 0.2)(D)
        return {
            "u": _w((lambda *s: torch.randn(*s, dtype=torch.bfloat16) * 0.05)(B, L, D)),
            "A_re": _w(A_re),
            "A_im": _w(A_im),
            "B_re": _w(B_re),
            "B_im": _w(B_im),
            "C_re": _w(C_re),
            "C_im": _w(C_im),
            "log_dt": _w(log_dt),
            "Dskip": _w(Dskip),
        }
    _A_in = _A_setup()

    def _B_setup():
        B, S, D, F = 1, 2048, 512, 1792
        return {
            "x": _w((lambda *s: torch.randn(*s, dtype=torch.bfloat16) * 0.05)(B, S, D)),
            "w1": _w((lambda *s: torch.randn(*s, dtype=torch.bfloat16) * 0.8)(S, F) * (S ** -0.5)),
            "b1": _w((lambda *s: torch.randn(*s, dtype=torch.bfloat16) * 12.8)(F) * 0.02),
            "w2": _w((lambda *s: torch.randn(*s, dtype=torch.bfloat16) * 0.2)(F, S) * (F ** -0.5)),
            "b2": _w((lambda *s: torch.randn(*s, dtype=torch.bfloat16) * 1.6)(S) * 0.02),
        }
    _B_in = _B_setup()

    return {
        "A_u": _A_in["u"],
        "A_A_re": _A_in["A_re"],
        "A_A_im": _A_in["A_im"],
        "A_B_re": _A_in["B_re"],
        "A_B_im": _A_in["B_im"],
        "A_C_re": _A_in["C_re"],
        "A_C_im": _A_in["C_im"],
        "A_log_dt": _A_in["log_dt"],
        "A_Dskip": _A_in["Dskip"],
        "B_x": _B_in["x"],
        "B_w1": _B_in["w1"],
        "B_b1": _B_in["b1"],
        "B_w2": _B_in["w2"],
        "B_b2": _B_in["b2"],
    }

def reference(A_u, A_A_re, A_A_im, A_B_re, A_B_im, A_C_re, A_C_im, A_log_dt, A_Dskip, B_x, B_w1, B_b1, B_w2, B_b2):
    def _A_ref(u, A_re, A_im, B_re, B_im, C_re, C_im, log_dt, Dskip):
        Bsz, L, D = u.shape
        dt = torch.exp(log_dt)[:, None]
        A = A_re + 1j * A_im
        Bc = B_re + 1j * B_im
        Cc = C_re + 1j * C_im
        logdA = dt * A
        dB = dt * Bc
        l = (lambda x, dt: x.to(dt))(torch.arange(L), A_re.dtype)
        P = torch.exp(logdA[:, :, None] * l[None, None, :])
        K = torch.einsum("dn,dnl,dn->dl", Cc, P, dB).real
        L2 = 2 * L
        Kp = _pad(K, ((0, 0), (0, L)))
        up = (lambda x, *d: x.permute(*d))(u, 0, 2, 1)
        up = _pad(up, ((0, 0), (0, 0), (0, L)))
        Kf = (lambda x, axes=(-2,-1): torch.fft.rfft2(x.float(), dim=axes))(Kp[:, None, :], axes=(-2, -1))
        Uf = (lambda x, axes=(-2,-1): torch.fft.rfft2(x.float(), dim=axes))(up[:, :, None, :], axes=(-2, -1))
        Yf = Uf * Kf[None, :, :, :]
        y = (lambda x, s, axes=(-2,-1): torch.fft.irfft2(x, s=s, dim=axes).to(torch.bfloat16))(Yf, (1, L2), axes=(-2, -1))[:, :, 0, :L]
        y = (lambda x, *d: x.permute(*d))(y, 0, 2, 1) + u * Dskip[None, None, :]
        return y

    def _B_ref(x, w1, b1, w2, b2):
        B, S, D = x.shape
        h = _layernorm(x, axis=-1)
        u = torch.einsum("bsd,sf->bdf", h, w1) + b1
        u = _gelu(u)
        y = torch.einsum("bdf,fs->bds", u, w2) + b2
        return (lambda x, *d: x.permute(*d))(y, 0, 2, 1)

    x = A_u
    xn = _layernorm(x, axis=-1)
    s = _A_ref(xn, A_A_re, A_A_im, A_B_re, A_B_im, A_C_re, A_C_im, A_log_dt, A_Dskip)
    g = _silu(_B_ref(xn, B_w1, B_b1, B_w2, B_b2))
    return x + s * g
```

```asm
; @launch grid=(256,1,1) block=(512,1,1) lds=163840
.amdgcn_target "amdgcn-amd-amdhsa--gfx950"
.text
.globl recurrent_scan__ssm_conv_s4__mixer_token_mlp__prompt_kernel
.p2align 8
.type recurrent_scan__ssm_conv_s4__mixer_token_mlp__prompt_kernel,@function
recurrent_scan__ssm_conv_s4__mixer_token_mlp__prompt_kernel:
    s_cmp_ge_u32 s2, 256
    s_cbranch_scc1 L_end
    s_load_dwordx16 s[16:31], s[0:1], 0
    s_load_dwordx16 s[32:47], s[0:1], 64
    s_load_dwordx2 s[48:49], s[0:1], 128
    v_lshrrev_b32 v1, 6, v0
    v_and_b32 v0, 63, v0
    v_readfirstlane_b32 s3, v1
    v_lshlrev_b32 v1, 4, v0
    v_and_b32 v8, 31, v0
    v_lshrrev_b32 v9, 5, v0
    v_lshlrev_b32 v10, 2, v8
    s_lshl_b32 s4, s2, 3
    s_add_u32 s4, s4, s3
    s_lshl_b32 s4, s4, 10
    v_add_u32 v22, s4, v1
    s_waitcnt lgkmcnt(0)
    global_load_dwordx4 v[24:27], v22, s[16:17]
    s_and_b32 s5, s2, 7
    s_lshr_b32 s6, s2, 3
    s_lshl_b32 s70, s3, 14
    s_lshl_b32 s7, s5, 5
    s_add_u32 s7, s7, s6
    s_lshr_b32 s8, s3, 2
    s_lshl_b32 s9, s7, 1
    s_add_u32 s9, s9, s8
    s_bfe_u32 s10, s3, 0x10001
    s_lshl_b32 s11, s9, 8
    s_lshl_b32 s12, s10, 7
    s_add_u32 s11, s11, s12
    v_lshlrev_b32 v20, 1, v0
    v_add_u32 v20, s11, v20
    s_lshl_b32 s11, s9, 1
    v_mov_b32 v21, s11
    v_mov_b32 v60, 0
    v_mov_b32 v61, 0
    v_mov_b32 v62, 0
    v_mov_b32 v63, 0
    v_mov_b32 v64, 1
    s_and_b32 s50, s5, 1
    s_lshl_b32 s50, s50, 2
    s_and_b32 s12, s6, 3
    s_add_u32 s50, s50, s12
    s_lshr_b32 s14, s5, 1
    s_lshr_b32 s15, s6, 2
    s_mul_i32 s51, s14, 7
    s_add_u32 s51, s51, s15
    s_lshl_b32 s75, s14, 3
    s_add_u32 s75, s75, s15
    s_lshl_b32 s71, s12, 1
    s_add_u32 s71, s71, s15
    s_and_b32 s71, s71, 7
    s_lshl_b32 s80, s3, 10
    s_lshl_b32 s12, s2, 2
    s_add_u32 s80, s80, s12
    s_add_u32 s80, s80, 0xc00000
    s_add_u32 s81, s80, 8192
    s_lshl_b32 s79, s50, 1
    s_add_u32 s79, s79, s10
    s_mul_i32 s79, s79, 112
    s_lshl_b32 s12, s51, 2
    s_add_u32 s79, s79, s12
    s_lshl_b32 s12, s8, 1
    s_add_u32 s79, s79, s12
    s_and_b32 s12, s3, 1
    s_add_u32 s79, s79, s12
    s_lshl_b32 s79, s79, 10
    s_add_u32 s79, s79, 0x800000
    s_add_u32 s12, s4, 0x400000
    s_cmp_eq_u32 s15, 7
    s_cselect_b32 s79, s12, s79
    s_lshl_b32 s83, s5, 10
    s_and_b32 s12, s3, 3
    s_lshl_b32 s12, s12, 8
    s_add_u32 s83, s83, s12
    s_lshl_b32 s12, s6, 3
    s_add_u32 s83, s83, s12
    s_lshl_b32 s12, s8, 2
    s_add_u32 s83, s83, s12
    s_add_u32 s83, s83, 0xc02000
    v_mov_b32 v56, -1
    v_mov_b32 v57, -1
    v_mov_b32 v58, -1
    v_mov_b32 v59, -1
    v_and_b32 v40, 15, v0
    v_lshrrev_b32 v41, 2, v40
    v_lshlrev_b32 v41, 7, v41
    v_lshl_add_u32 v41, v9, 10, v41
    v_bfe_u32 v42, v0, 4, 1
    v_lshl_add_u32 v41, v42, 5, v41
    v_and_b32 v42, 3, v40
    v_lshl_add_u32 v41, v42, 3, v41
    v_add_u32 v41, s70, v41
    v_lshrrev_b32 v42, 3, v40
    v_lshl_add_u32 v6, v42, 6, v41
    v_xor_b32 v42, 1, v42
    v_lshl_add_u32 v7, v42, 6, v41
    s_mov_b32 s76, 0x3727c5ac
    s_mov_b32 s77, 0x3b000000
    s_mul_i32 s12, s3, 1088
    s_add_u32 s12, s12, 131072
    v_add_u32 v38, s12, v1
    v_lshrrev_b32 v41, 2, v40
    v_mul_u32_u24 v39, 1088, v41
    v_lshrrev_b32 v41, 4, v0
    v_lshl_add_u32 v39, v41, 5, v39
    v_and_b32 v41, 3, v0
    v_lshl_add_u32 v39, v41, 3, v39
    s_lshl_b32 s12, s3, 7
    s_add_u32 s12, s12, 131072
    v_add_u32 v39, s12, v39
    v_lshlrev_b32 v37, 17, v9
    v_lshl_add_u32 v37, v8, 4, v37
    s_lshl_b32 s78, s3, 18
    s_lshl_b32 s12, s2, 9
    s_add_u32 s78, s78, s12
    v_add_u32 v36, 0x200000, v37
    s_waitcnt lgkmcnt(0)
    s_mov_b32 s56, s48
    s_mov_b32 s57, s49
    s_mov_b32 s58, 0xe00000
    s_mov_b32 s59, 0x00020000
    s_lshr_b32 s12, s40, 7
    s_sub_u32 s12, 3, s12
    s_and_b32 s12, s12, 7
    s_cmp_eq_u32 s15, s12
    s_cselect_b32 s75, 7, s15
    s_cmp_eq_u32 s15, 7
    s_cselect_b32 s75, s12, s75
    s_lshl_b32 s12, s14, 3
    s_add_u32 s75, s75, s12
    s_mov_b32 s52, s16
    s_mov_b32 s53, s17
    s_mov_b32 s54, 0x200000
    s_mov_b32 s55, 0x00020000
    s_sub_u32 s13, s2, 224
    s_lshr_b32 s12, s13, 3
    s_lshl_b32 s12, s12, 2
    s_and_b32 s13, s13, 7
    s_cmp_gt_u32 s13, 1
    s_cselect_b32 s12, 16, s12
    s_lshl_b32 s13, s13, 1
    s_add_u32 s13, s13, s12
    s_sub_u32 s12, s3, 6
    s_add_u32 s13, s13, s12
    s_cmp_lt_u32 s3, 6
    s_cselect_b32 s13, 16, s13
    s_cmp_lt_u32 s2, 224
    s_cselect_b32 s13, 16, s13
    s_cmp_ge_u32 s13, 16
    s_cbranch_scc1 L_nozero_1
    s_lshl_b32 s12, s13, 10
    s_add_u32 s12, s12, 0xc00000
    buffer_store_dwordx4 v[60:63], v1, s[56:59], s12 offen sc1
L_nozero_1:
    global_load_ushort v28, v20, s[18:19]
    global_load_ushort v29, v20, s[20:21]
    global_load_ushort v30, v20, s[22:23]
    global_load_ushort v31, v20, s[24:25]
    global_load_ushort v32, v20, s[26:27]
    global_load_ushort v33, v20, s[28:29]
    global_load_ushort v34, v21, s[30:31]
    global_load_ushort v11, v21, s[32:33]
    buffer_store_dwordx4 v[56:59], v1, s[56:59], s79 offen sc1
    s_mov_b32 s60, s36
    s_mov_b32 s61, s37
    s_mov_b32 s62, 0x700000
    s_mov_b32 s63, 0x00020000
    v_lshrrev_b32 v3, 3, v0
    v_mul_u32_u24 v3, 3584, v3
    v_and_b32 v4, 7, v0
    v_lshrrev_b32 v5, 4, v0
    v_and_b32 v5, 1, v5
    v_lshlrev_b32 v5, 2, v5
    v_xor_b32 v4, v4, v5
    v_lshl_add_u32 v2, v4, 4, v3
    v_add_u32 v3, 27648, v2
    v_add_u32 v4, 55296, v2
    v_add_u32 v5, 82944, v2
    s_mov_b32 s72, s71
    s_mul_i32 s64, s3, 917504
    s_lshl_b32 s73, s51, 7
    s_add_u32 s64, s64, s73
    s_add_u32 s65, s64, 917504
    s_mov_b32 s66, s64
    s_mul_i32 s73, s72, 114688
    s_add_u32 s64, s64, s73
    s_mul_i32 s67, s50, 262144
    s_mul_i32 s73, s3, 16384
    s_add_u32 s67, s67, s73
    s_add_u32 s67, s67, 0x0
    s_add_u32 s69, s67, 16384
    s_mov_b32 s74, s67
    s_lshl_b32 s73, s72, 11
    s_add_u32 s67, s67, s73
    s_add_u32 s68, s67, 131072
    s_cmp_eq_u32 s15, 7
    s_cbranch_scc0 L_nogxs_2
    s_mov_b32 s60, s40
    s_mov_b32 s61, s41
    s_mov_b32 s62, 0x700000
    s_mov_b32 s63, 0x00020000
    s_cmp_eq_u32 s3, 7
    s_cselect_b32 s62, 0, s62
    s_sub_u32 s12, s2, 224
    s_lshr_b32 s64, s12, 2
    s_mul_i32 s64, s64, 224
    s_and_b32 s12, s12, 3
    s_mul_i32 s12, s12, 7
    s_add_u32 s64, s64, s12
    s_add_u32 s64, s64, s3
    s_lshl_b32 s64, s64, 12
    s_mov_b32 s66, s64
    s_add_u32 s65, s64, 917504
    s_and_b32 s12, s75, 7
    v_lshrrev_b32 v3, 3, v0
    v_cmp_eq_u32 vcc, s12, v3
    v_mov_b32 v3, 0x40000000
    s_nop 0
    v_cndmask_b32 v2, v1, v3, vcc
    v_mov_b32 v3, v2
    v_mov_b32 v4, v2
    v_mov_b32 v5, v2
L_nogxs_2:
    s_cmp_ge_u32 s13, 16
    s_cbranch_scc1 L_nozero2_3
    s_lshl_b32 s12, s13, 3
    v_mov_b32 v65, s12
    s_waitcnt vmcnt(9)
    s_mov_b64 exec, 1
    global_store_dword v65, v64, s[46:47] sc1
    s_mov_b64 exec, -1
L_nozero2_3:
    s_setprio 0
    s_waitcnt vmcnt(9)
    v_lshlrev_b32 v40, 16, v24
    v_and_b32 v41, 0xffff0000, v24
    v_lshlrev_b32 v42, 16, v25
    v_and_b32 v43, 0xffff0000, v25
    s_add_u32 m0, s70, 0
    s_nop 0
    buffer_load_dwordx4 v2, s[60:63], s64 offen offset:0 lds
    v_lshlrev_b32 v44, 16, v26
    v_and_b32 v45, 0xffff0000, v26
    v_lshlrev_b32 v46, 16, v27
    v_and_b32 v47, 0xffff0000, v27
    v_pk_add_f32 v[48:49], v[40:41], v[42:43]
    v_pk_add_f32 v[50:51], v[44:45], v[46:47]
    v_pk_add_f32 v[48:49], v[48:49], v[50:51]
    v_add_f32 v52, v48, v49
    buffer_load_dwordx4 v3, s[60:63], s64 offen offset:1024 lds
    s_nop 0
    v_add_f32_dpp v53, v52, v52 quad_perm:[1,0,3,2] row_mask:0xf bank_mask:0xf
    s_nop 1
    v_add_f32_dpp v52, v53, v53 quad_perm:[2,3,0,1] row_mask:0xf bank_mask:0xf
    s_nop 1
    v_add_f32_dpp v53, v52, v52 row_half_mirror row_mask:0xf bank_mask:0xf
    s_nop 1
    v_add_f32_dpp v52, v53, v53 row_mirror row_mask:0xf bank_mask:0xf
    v_mov_b32 v53, v52
    s_nop 1
    v_permlane16_swap_b32 v53, v52
    v_add_f32 v52, v52, v53
    v_mov_b32 v53, v52
    buffer_load_dwordx4 v4, s[60:63], s64 offen offset:2048 lds
    s_nop 0
    v_permlane32_swap_b32 v53, v52
    v_add_f32 v52, v52, v53
    v_mul_f32 v54, s77, v52
    v_pk_add_f32 v[60:61], v[40:41], v[54:55] op_sel:[0,0] op_sel_hi:[1,0] neg_lo:[0,1] neg_hi:[0,1]
    v_pk_mul_f32 v[48:49], v[60:61], v[60:61]
    v_pk_add_f32 v[62:63], v[42:43], v[54:55] op_sel:[0,0] op_sel_hi:[1,0] neg_lo:[0,1] neg_hi:[0,1]
    v_pk_mul_f32 v[50:51], v[62:63], v[62:63]
    v_pk_add_f32 v[60:61], v[44:45], v[54:55] op_sel:[0,0] op_sel_hi:[1,0] neg_lo:[0,1] neg_hi:[0,1]
    buffer_load_dwordx4 v5, s[60:63], s64 offen offset:3072 lds
    s_add_u32 s64, s64, 114688
    s_cmp_eq_u32 s64, s65
    s_cselect_b32 s64, s66, s64
    v_pk_fma_f32 v[48:49], v[60:61], v[60:61], v[48:49]
    v_pk_add_f32 v[62:63], v[46:47], v[54:55] op_sel:[0,0] op_sel_hi:[1,0] neg_lo:[0,1] neg_hi:[0,1]
    v_pk_fma_f32 v[50:51], v[62:63], v[62:63], v[50:51]
    v_pk_add_f32 v[48:49], v[48:49], v[50:51]
    v_add_f32 v52, v48, v49
    s_nop 1
    v_add_f32_dpp v53, v52, v52 quad_perm:[1,0,3,2] row_mask:0xf bank_mask:0xf
    s_nop 1
    v_add_f32_dpp v52, v53, v53 quad_perm:[2,3,0,1] row_mask:0xf bank_mask:0xf
    s_nop 1
    v_add_f32_dpp v53, v52, v52 row_half_mirror row_mask:0xf bank_mask:0xf
    s_nop 1
    v_add_f32_dpp v52, v53, v53 row_mirror row_mask:0xf bank_mask:0xf
    v_mov_b32 v53, v52
    s_nop 1
    v_permlane16_swap_b32 v53, v52
    v_add_f32 v52, v52, v53
    v_mov_b32 v53, v52
    s_nop 1
    v_permlane32_swap_b32 v53, v52
    v_add_f32 v52, v52, v53
    v_mul_f32 v52, s77, v52
    v_cvt_pk_bf16_f32 v53, v54, v52
    v_lshlrev_b32 v54, 16, v53
    v_and_b32 v52, 0xffff0000, v53
    v_add_f32 v52, s76, v52
    v_pk_add_f32 v[40:41], v[40:41], v[54:55] op_sel:[0,0] op_sel_hi:[1,0] neg_lo:[0,1] neg_hi:[0,1]
    v_cvt_pk_bf16_f32 v53, v52, v52
    v_pk_add_f32 v[42:43], v[42:43], v[54:55] op_sel:[0,0] op_sel_hi:[1,0] neg_lo:[0,1] neg_hi:[0,1]
    v_lshlrev_b32 v52, 16, v53
    v_pk_add_f32 v[44:45], v[44:45], v[54:55] op_sel:[0,0] op_sel_hi:[1,0] neg_lo:[0,1] neg_hi:[0,1]
    v_sqrt_f32 v52, v52
    v_pk_add_f32 v[46:47], v[46:47], v[54:55] op_sel:[0,0] op_sel_hi:[1,0] neg_lo:[0,1] neg_hi:[0,1]
    v_cvt_pk_bf16_f32 v66, v40, v41
    v_cvt_pk_bf16_f32 v53, v52, v52
    v_cvt_pk_bf16_f32 v67, v42, v43
    v_lshlrev_b32 v56, 16, v53
    v_cvt_pk_bf16_f32 v68, v44, v45
    v_rcp_f32 v58, v56
    v_cvt_pk_bf16_f32 v69, v46, v47
    v_lshlrev_b32 v40, 16, v66
    v_and_b32 v41, 0xffff0000, v66
    v_lshlrev_b32 v42, 16, v67
    v_and_b32 v43, 0xffff0000, v67
    v_lshlrev_b32 v44, 16, v68
    v_and_b32 v45, 0xffff0000, v68
    v_lshlrev_b32 v46, 16, v69
    v_and_b32 v47, 0xffff0000, v69
    v_pk_mul_f32 v[48:49], v[40:41], v[58:59] op_sel:[0,0] op_sel_hi:[1,0]
    v_pk_mul_f32 v[50:51], v[42:43], v[58:59] op_sel:[0,0] op_sel_hi:[1,0]
    v_pk_mul_f32 v[60:61], v[44:45], v[58:59] op_sel:[0,0] op_sel_hi:[1,0]
    v_pk_mul_f32 v[62:63], v[46:47], v[58:59] op_sel:[0,0] op_sel_hi:[1,0]
    v_pk_fma_f32 v[40:41], v[48:49], v[56:57], v[40:41] op_sel:[0,0,0] op_sel_hi:[1,0,1] neg_lo:[1,0,0] neg_hi:[1,0,0]
    v_pk_fma_f32 v[42:43], v[50:51], v[56:57], v[42:43] op_sel:[0,0,0] op_sel_hi:[1,0,1] neg_lo:[1,0,0] neg_hi:[1,0,0]
    v_pk_fma_f32 v[44:45], v[60:61], v[56:57], v[44:45] op_sel:[0,0,0] op_sel_hi:[1,0,1] neg_lo:[1,0,0] neg_hi:[1,0,0]
    v_pk_fma_f32 v[46:47], v[62:63], v[56:57], v[46:47] op_sel:[0,0,0] op_sel_hi:[1,0,1] neg_lo:[1,0,0] neg_hi:[1,0,0]
    v_pk_fma_f32 v[40:41], v[40:41], v[58:59], v[48:49] op_sel:[0,0,0] op_sel_hi:[1,0,1]
    v_pk_fma_f32 v[42:43], v[42:43], v[58:59], v[50:51] op_sel:[0,0,0] op_sel_hi:[1,0,1]
    v_pk_fma_f32 v[44:45], v[44:45], v[58:59], v[60:61] op_sel:[0,0,0] op_sel_hi:[1,0,1]
    v_pk_fma_f32 v[46:47], v[46:47], v[58:59], v[62:63] op_sel:[0,0,0] op_sel_hi:[1,0,1]
    v_cvt_pk_bf16_f32 v66, v40, v41
    v_cvt_pk_bf16_f32 v67, v42, v43
    v_cvt_pk_bf16_f32 v68, v44, v45
    v_cvt_pk_bf16_f32 v69, v46, v47
    v_lshlrev_b32 v40, 16, v66
    v_and_b32 v41, 0xffff0000, v66
    v_lshlrev_b32 v42, 16, v67
    v_and_b32 v43, 0xffff0000, v67
    v_lshlrev_b32 v44, 16, v68
    v_and_b32 v45, 0xffff0000, v68
    v_lshlrev_b32 v46, 16, v69
    v_and_b32 v47, 0xffff0000, v69
    v_cvt_pk_f16_f32 v76, v40, v41
    v_cvt_pk_f16_f32 v77, v42, v43
    v_cvt_pk_f16_f32 v78, v44, v45
    v_cvt_pk_f16_f32 v79, v46, v47
    ds_write_b128 v38, v[76:79] offset:8704
    v_pk_add_f32 v[48:49], v[40:41], v[42:43]
    v_pk_add_f32 v[50:51], v[44:45], v[46:47]
    v_pk_add_f32 v[48:49], v[48:49], v[50:51]
    v_add_f32 v52, v48, v49
    s_nop 1
    v_add_f32_dpp v53, v52, v52 quad_perm:[1,0,3,2] row_mask:0xf bank_mask:0xf
    s_nop 1
    v_add_f32_dpp v52, v53, v53 quad_perm:[2,3,0,1] row_mask:0xf bank_mask:0xf
    s_nop 1
    v_add_f32_dpp v53, v52, v52 row_half_mirror row_mask:0xf bank_mask:0xf
    s_nop 1
    v_add_f32_dpp v52, v53, v53 row_mirror row_mask:0xf bank_mask:0xf
    v_mov_b32 v53, v52
    s_nop 1
    v_permlane16_swap_b32 v53, v52
    v_add_f32 v52, v52, v53
    v_mov_b32 v53, v52
    s_nop 1
    v_permlane32_swap_b32 v53, v52
    v_add_f32 v52, v52, v53
    v_mul_f32 v54, s77, v52
    v_pk_add_f32 v[60:61], v[40:41], v[54:55] op_sel:[0,0] op_sel_hi:[1,0] neg_lo:[0,1] neg_hi:[0,1]
    v_pk_mul_f32 v[48:49], v[60:61], v[60:61]
    v_pk_add_f32 v[62:63], v[42:43], v[54:55] op_sel:[0,0] op_sel_hi:[1,0] neg_lo:[0,1] neg_hi:[0,1]
    v_pk_mul_f32 v[50:51], v[62:63], v[62:63]
    v_pk_add_f32 v[60:61], v[44:45], v[54:55] op_sel:[0,0] op_sel_hi:[1,0] neg_lo:[0,1] neg_hi:[0,1]
    v_pk_fma_f32 v[48:49], v[60:61], v[60:61], v[48:49]
    v_pk_add_f32 v[62:63], v[46:47], v[54:55] op_sel:[0,0] op_sel_hi:[1,0] neg_lo:[0,1] neg_hi:[0,1]
    v_pk_fma_f32 v[50:51], v[62:63], v[62:63], v[50:51]
    v_pk_add_f32 v[48:49], v[48:49], v[50:51]
    v_add_f32 v52, v48, v49
    s_nop 1
    v_add_f32_dpp v53, v52, v52 quad_perm:[1,0,3,2] row_mask:0xf bank_mask:0xf
    s_nop 1
    v_add_f32_dpp v52, v53, v53 quad_perm:[2,3,0,1] row_mask:0xf bank_mask:0xf
    s_nop 1
    v_add_f32_dpp v53, v52, v52 row_half_mirror row_mask:0xf bank_mask:0xf
    s_nop 1
    v_add_f32_dpp v52, v53, v53 row_mirror row_mask:0xf bank_mask:0xf
    v_mov_b32 v53, v52
    s_nop 1
    v_permlane16_swap_b32 v53, v52
    v_add_f32 v52, v52, v53
    v_mov_b32 v53, v52
    s_nop 1
    v_permlane32_swap_b32 v53, v52
    v_add_f32 v52, v52, v53
    v_mul_f32 v52, s77, v52
    v_cvt_pk_bf16_f32 v53, v54, v52
    v_lshlrev_b32 v54, 16, v53
    v_and_b32 v52, 0xffff0000, v53
    v_add_f32 v52, s76, v52
    v_pk_add_f32 v[40:41], v[40:41], v[54:55] op_sel:[0,0] op_sel_hi:[1,0] neg_lo:[0,1] neg_hi:[0,1]
    v_cvt_pk_bf16_f32 v53, v52, v52
    v_pk_add_f32 v[42:43], v[42:43], v[54:55] op_sel:[0,0] op_sel_hi:[1,0] neg_lo:[0,1] neg_hi:[0,1]
    v_lshlrev_b32 v52, 16, v53
    v_pk_add_f32 v[44:45], v[44:45], v[54:55] op_sel:[0,0] op_sel_hi:[1,0] neg_lo:[0,1] neg_hi:[0,1]
    v_sqrt_f32 v52, v52
    v_pk_add_f32 v[46:47], v[46:47], v[54:55] op_sel:[0,0] op_sel_hi:[1,0] neg_lo:[0,1] neg_hi:[0,1]
    v_cvt_pk_bf16_f32 v72, v40, v41
    v_cvt_pk_bf16_f32 v53, v52, v52
    v_cvt_pk_bf16_f32 v73, v42, v43
    v_lshlrev_b32 v56, 16, v53
    v_cvt_pk_bf16_f32 v74, v44, v45
    v_rcp_f32 v58, v56
    v_cvt_pk_bf16_f32 v75, v46, v47
    v_lshlrev_b32 v40, 16, v72
    v_and_b32 v41, 0xffff0000, v72
    v_lshlrev_b32 v42, 16, v73
    v_and_b32 v43, 0xffff0000, v73
    v_lshlrev_b32 v44, 16, v74
    v_and_b32 v45, 0xffff0000, v74
    v_lshlrev_b32 v46, 16, v75
    v_and_b32 v47, 0xffff0000, v75
    v_pk_mul_f32 v[48:49], v[40:41], v[58:59] op_sel:[0,0] op_sel_hi:[1,0]
    v_pk_mul_f32 v[50:51], v[42:43], v[58:59] op_sel:[0,0] op_sel_hi:[1,0]
    v_pk_mul_f32 v[60:61], v[44:45], v[58:59] op_sel:[0,0] op_sel_hi:[1,0]
    v_pk_mul_f32 v[62:63], v[46:47], v[58:59] op_sel:[0,0] op_sel_hi:[1,0]
    v_pk_fma_f32 v[40:41], v[48:49], v[56:57], v[40:41] op_sel:[0,0,0] op_sel_hi:[1,0,1] neg_lo:[1,0,0] neg_hi:[1,0,0]
    v_pk_fma_f32 v[42:43], v[50:51], v[56:57], v[42:43] op_sel:[0,0,0] op_sel_hi:[1,0,1] neg_lo:[1,0,0] neg_hi:[1,0,0]
    v_pk_fma_f32 v[44:45], v[60:61], v[56:57], v[44:45] op_sel:[0,0,0] op_sel_hi:[1,0,1] neg_lo:[1,0,0] neg_hi:[1,0,0]
    v_pk_fma_f32 v[46:47], v[62:63], v[56:57], v[46:47] op_sel:[0,0,0] op_sel_hi:[1,0,1] neg_lo:[1,0,0] neg_hi:[1,0,0]
    v_pk_fma_f32 v[40:41], v[40:41], v[58:59], v[48:49] op_sel:[0,0,0] op_sel_hi:[1,0,1]
    v_pk_fma_f32 v[42:43], v[42:43], v[58:59], v[50:51] op_sel:[0,0,0] op_sel_hi:[1,0,1]
    v_pk_fma_f32 v[44:45], v[44:45], v[58:59], v[60:61] op_sel:[0,0,0] op_sel_hi:[1,0,1]
    v_pk_fma_f32 v[46:47], v[46:47], v[58:59], v[62:63] op_sel:[0,0,0] op_sel_hi:[1,0,1]
    v_cvt_pk_bf16_f32 v72, v40, v41
    v_cvt_pk_bf16_f32 v73, v42, v43
    v_cvt_pk_bf16_f32 v74, v44, v45
    v_cvt_pk_bf16_f32 v75, v46, v47
    ds_write_b128 v38, v[72:75]
    s_waitcnt lgkmcnt(0)
    s_barrier
    ds_read_b64_tr_b16 v[40:41], v39
    ds_read_b64_tr_b16 v[42:43], v39 offset:4352
    ds_read_b64_tr_b16 v[44:45], v39 offset:8704
    ds_read_b64_tr_b16 v[46:47], v39 offset:13056
    s_waitcnt lgkmcnt(2)
    buffer_store_dwordx4 v[40:43], v37, s[56:59], s78 offen sc1
    s_waitcnt lgkmcnt(0)
    buffer_store_dwordx4 v[44:47], v36, s[56:59], s78 offen sc1
    v_min_u32 v12, 60, v10
    v_lshlrev_b32 v12, 1, v12
    s_cmp_lg_u32 s3, 3
    s_cbranch_scc1 L_noz_4
    global_load_dword v13, v12, s[46:47] sc1
L_noz_4:
    v_add_u32 v15, s70, v1
    s_setprio 0
    s_mov_b32 s16, 0x3fb8aa3b
    s_mov_b32 s17, 0x32a57060
    s_mov_b32 s18, 0x3e22f983
    s_mov_b32 s19, 0x31dc9c88
    s_waitcnt vmcnt(7)
    v_lshlrev_b32 v28, 16, v28
    v_lshlrev_b32 v29, 16, v29
    v_lshlrev_b32 v30, 16, v30
    v_lshlrev_b32 v31, 16, v31
    v_lshlrev_b32 v32, 16, v32
    v_lshlrev_b32 v33, 16, v33
    v_lshlrev_b32 v34, 16, v34
    v_mul_f32 v48, s16, v34
    v_fma_f32 v49, v34, s16, -v48
    v_fmac_f32 v49, s17, v34
    v_exp_f32 v50, v48
    v_mul_f32 v49, 0x3f317218, v49
    v_add_u32 v35, s70, v1
    v_fmac_f32 v50, v49, v50
    v_cvt_pk_bf16_f32 v50, v50, v50
    v_lshlrev_b32 v34, 16, v50
    v_mul_f32 v28, v34, v28
    v_mul_f32 v29, v34, v29
    v_mul_f32 v30, v34, v30
    v_mul_f32 v31, v34, v31
    v_pk_mul_f32 v[48:49], v[32:33], v[30:31] op_sel:[0,0] op_sel_hi:[0,1]
    v_pk_fma_f32 v[80:81], v[32:33], v[30:31], v[48:49] op_sel:[1,1,0] op_sel_hi:[1,0,1] neg_lo:[0,1,0]
    v_mul_f32 v28, s16, v28
    v_mul_f32 v30, s18, v29
    v_fma_f32 v31, v29, s18, -v30
    v_fmac_f32 v31, s19, v29
    v_ldexp_f32 v80, v80, 10
    v_ldexp_f32 v81, v81, 10
    s_bitcmp1_b32 s3, 0
    s_cbranch_scc1 L_partB_5
    v_ldexp_f32 v56, v28, 0
    v_ldexp_f32 v60, v28, 4
    v_ldexp_f32 v57, v30, 0
    v_ldexp_f32 v61, v30, 4
    v_ldexp_f32 v58, v31, 0
    v_ldexp_f32 v62, v31, 4
    v_exp_f32 v56, v56
    v_exp_f32 v60, v60
    v_fract_f32 v57, v57
    v_fract_f32 v61, v61
    v_add_f32 v57, v57, v58
    v_add_f32 v61, v61, v62
    v_cos_f32 v82, v57
    v_cos_f32 v84, v61
    v_sin_f32 v83, v57
    v_sin_f32 v85, v61
    v_mul_f32 v82, v56, v82
    v_mul_f32 v84, v60, v84
    v_mul_f32 v83, v56, v83
    v_mul_f32 v85, v60, v85
    s_add_u32 m0, s70, 4096
    s_nop 0
    buffer_load_dwordx4 v2, s[60:63], s64 offen offset:0 lds
    v_pk_mul_f32 v[50:51], v[82:83], v[82:83] op_sel:[0,0] op_sel_hi:[0,1]
    v_pk_fma_f32 v[86:87], v[82:83], v[82:83], v[50:51] op_sel:[1,1,0] op_sel_hi:[1,0,1] neg_lo:[0,1,0]
    v_pk_mul_f32 v[52:53], v[84:85], v[84:85] op_sel:[0,0] op_sel_hi:[0,1]
    v_pk_fma_f32 v[92:93], v[84:85], v[84:85], v[52:53] op_sel:[1,1,0] op_sel_hi:[1,0,1] neg_lo:[0,1,0]
    v_pk_mul_f32 v[54:55], v[86:87], v[86:87] op_sel:[0,0] op_sel_hi:[0,1]
    v_pk_fma_f32 v[88:89], v[86:87], v[86:87], v[54:55] op_sel:[1,1,0] op_sel_hi:[1,0,1] neg_lo:[0,1,0]
    v_pk_mul_f32 v[48:49], v[92:93], v[92:93] op_sel:[0,0] op_sel_hi:[0,1]
    v_pk_fma_f32 v[94:95], v[92:93], v[92:93], v[48:49] op_sel:[1,1,0] op_sel_hi:[1,0,1] neg_lo:[0,1,0]
    v_pk_mul_f32 v[50:51], v[88:89], v[88:89] op_sel:[0,0] op_sel_hi:[0,1]
    v_pk_fma_f32 v[90:91], v[88:89], v[88:89], v[50:51] op_sel:[1,1,0] op_sel_hi:[1,0,1] neg_lo:[0,1,0]
    v_pk_mul_f32 v[52:53], v[94:95], v[94:95] op_sel:[0,0] op_sel_hi:[0,1]
    v_pk_fma_f32 v[96:97], v[94:95], v[94:95], v[52:53] op_sel:[1,1,0] op_sel_hi:[1,0,1] neg_lo:[0,1,0]
    v_pk_mul_f32 v[54:55], v[80:81], v[82:83] op_sel:[0,0] op_sel_hi:[0,1]
    v_pk_fma_f32 v[98:99], v[80:81], v[82:83], v[54:55] op_sel:[1,1,0] op_sel_hi:[1,0,1] neg_lo:[0,1,0]
    v_pk_mul_f32 v[48:49], v[80:81], v[86:87] op_sel:[0,0] op_sel_hi:[0,1]
    v_pk_fma_f32 v[100:101], v[80:81], v[86:87], v[48:49] op_sel:[1,1,0] op_sel_hi:[1,0,1] neg_lo:[0,1,0]
    v_pk_mul_f32 v[50:51], v[80:81], v[88:89] op_sel:[0,0] op_sel_hi:[0,1]
    v_pk_fma_f32 v[102:103], v[80:81], v[88:89], v[50:51] op_sel:[1,1,0] op_sel_hi:[1,0,1] neg_lo:[0,1,0]
    v_pk_mul_f32 v[52:53], v[100:101], v[82:83] op_sel:[0,0] op_sel_hi:[0,1]
    v_pk_fma_f32 v[104:105], v[100:101], v[82:83], v[52:53] op_sel:[1,1,0] op_sel_hi:[1,0,1] neg_lo:[0,1,0]
    v_pk_mul_f32 v[54:55], v[102:103], v[82:83] op_sel:[0,0] op_sel_hi:[0,1]
    v_pk_fma_f32 v[106:107], v[102:103], v[82:83], v[54:55] op_sel:[1,1,0] op_sel_hi:[1,0,1] neg_lo:[0,1,0]
    v_pk_mul_f32 v[48:49], v[102:103], v[86:87] op_sel:[0,0] op_sel_hi:[0,1]
    v_pk_fma_f32 v[108:109], v[102:103], v[86:87], v[48:49] op_sel:[1,1,0] op_sel_hi:[1,0,1] neg_lo:[0,1,0]
    v_pk_mul_f32 v[50:51], v[108:109], v[82:83] op_sel:[0,0] op_sel_hi:[0,1]
    v_pk_fma_f32 v[110:111], v[108:109], v[82:83], v[50:51] op_sel:[1,1,0] op_sel_hi:[1,0,1] neg_lo:[0,1,0]
    v_cvt_pk_f16_f32 v64, v80, v98
    v_cvt_pk_f16_f32 v65, v100, v104
    v_cvt_pk_f16_f32 v66, v102, v106
    v_cvt_pk_f16_f32 v67, v108, v110
    ds_write_b128 v35, v[64:67] offset:12288
    v_cvt_pk_f16_f32 v68, v81, v99
    v_cvt_pk_f16_f32 v69, v101, v105
    v_cvt_pk_f16_f32 v70, v103, v107
    v_cvt_pk_f16_f32 v71, v109, v111
    ds_write_b128 v35, v[68:71] offset:13312
    v_pk_mul_f32 v[52:53], v[80:81], v[96:97] op_sel:[0,0] op_sel_hi:[0,1]
    v_pk_fma_f32 v[80:81], v[80:81], v[96:97], v[52:53] op_sel:[1,1,0] op_sel_hi:[1,0,1] neg_lo:[0,1,0]
    v_pk_mul_f32 v[54:55], v[98:99], v[96:97] op_sel:[0,0] op_sel_hi:[0,1]
    v_pk_fma_f32 v[98:99], v[98:99], v[96:97], v[54:55] op_sel:[1,1,0] op_sel_hi:[1,0,1] neg_lo:[0,1,0]
    v_pk_mul_f32 v[48:49], v[100:101], v[96:97] op_sel:[0,0] op_sel_hi:[0,1]
    v_pk_fma_f32 v[100:101], v[100:101], v[96:97], v[48:49] op_sel:[1,1,0] op_sel_hi:[1,0,1] neg_lo:[0,1,0]
    v_pk_mul_f32 v[50:51], v[104:105], v[96:97] op_sel:[0,0] op_sel_hi:[0,1]
    v_pk_fma_f32 v[104:105], v[104:105], v[96:97], v[50:51] op_sel:[1,1,0] op_sel_hi:[1,0,1] neg_lo:[0,1,0]
    v_pk_mul_f32 v[52:53], v[102:103], v[96:97] op_sel:[0,0] op_sel_hi:[0,1]
    v_pk_fma_f32 v[102:103], v[102:103], v[96:97], v[52:53] op_sel:[1,1,0] op_sel_hi:[1,0,1] neg_lo:[0,1,0]
    v_pk_mul_f32 v[54:55], v[106:107], v[96:97] op_sel:[0,0] op_sel_hi:[0,1]
    v_pk_fma_f32 v[106:107], v[106:107], v[96:97], v[54:55] op_sel:[1,1,0] op_sel_hi:[1,0,1] neg_lo:[0,1,0]
    v_pk_mul_f32 v[48:49], v[108:109], v[96:97] op_sel:[0,0] op_sel_hi:[0,1]
    v_pk_fma_f32 v[108:109], v[108:109], v[96:97], v[48:49] op_sel:[1,1,0] op_sel_hi:[1,0,1] neg_lo:[0,1,0]
    v_pk_mul_f32 v[50:51], v[110:111], v[96:97] op_sel:[0,0] op_sel_hi:[0,1]
    v_pk_fma_f32 v[110:111], v[110:111], v[96:97], v[50:51] op_sel:[1,1,0] op_sel_hi:[1,0,1] neg_lo:[0,1,0]
    v_cvt_pk_f16_f32 v72, v80, v98
    v_cvt_pk_f16_f32 v73, v100, v104
    v_cvt_pk_f16_f32 v74, v102, v106
    v_cvt_pk_f16_f32 v75, v108, v110
    ds_write_b128 v35, v[72:75] offset:14336
    v_cvt_pk_f16_f32 v76, v81, v99
    v_cvt_pk_f16_f32 v77, v101, v105
    v_cvt_pk_f16_f32 v78, v103, v107
    buffer_load_dwordx4 v3, s[60:63], s64 offen offset:1024 lds
    v_cvt_pk_f16_f32 v79, v109, v111
    ds_write_b128 v35, v[76:79] offset:15360
    v_mov_b32 v80, 1.0
    v_mov_b32 v81, 0
    v_pk_mul_f32 v[52:53], v[84:85], v[90:91] op_sel:[0,0] op_sel_hi:[0,1]
    v_pk_fma_f32 v[104:105], v[84:85], v[90:91], v[52:53] op_sel:[1,1,0] op_sel_hi:[1,0,1] neg_lo:[0,1,0]
    v_pk_mul_f32 v[54:55], v[92:93], v[90:91] op_sel:[0,0] op_sel_hi:[0,1]
    v_pk_fma_f32 v[106:107], v[92:93], v[90:91], v[54:55] op_sel:[1,1,0] op_sel_hi:[1,0,1] neg_lo:[0,1,0]
    v_pk_mul_f32 v[48:49], v[92:93], v[84:85] op_sel:[0,0] op_sel_hi:[0,1]
    v_pk_fma_f32 v[108:109], v[92:93], v[84:85], v[48:49] op_sel:[1,1,0] op_sel_hi:[1,0,1] neg_lo:[0,1,0]
    v_pk_mul_f32 v[50:51], v[92:93], v[104:105] op_sel:[0,0] op_sel_hi:[0,1]
    v_pk_fma_f32 v[110:111], v[92:93], v[104:105], v[50:51] op_sel:[1,1,0] op_sel_hi:[1,0,1] neg_lo:[0,1,0]
    v_cvt_pk_f16_f32 v64, v80, v90
    v_cvt_pk_f16_f32 v65, v84, v104
    v_cvt_pk_f16_f32 v66, v92, v106
    v_cvt_pk_f16_f32 v67, v108, v110
    ds_write_b128 v35, v[64:67] offset:8192
    v_cvt_pk_f16_f32 v68, -v81, -v91
    v_cvt_pk_f16_f32 v69, -v85, -v105
    v_cvt_pk_f16_f32 v70, -v93, -v107
    v_cvt_pk_f16_f32 v71, -v109, -v111
    ds_write_b128 v35, v[68:71] offset:9216
    v_pk_mul_f32 v[52:53], v[90:91], v[94:95] op_sel:[0,0] op_sel_hi:[0,1]
    v_pk_fma_f32 v[90:91], v[90:91], v[94:95], v[52:53] op_sel:[1,1,0] op_sel_hi:[1,0,1] neg_lo:[0,1,0]
    v_pk_mul_f32 v[54:55], v[84:85], v[94:95] op_sel:[0,0] op_sel_hi:[0,1]
    v_pk_fma_f32 v[84:85], v[84:85], v[94:95], v[54:55] op_sel:[1,1,0] op_sel_hi:[1,0,1] neg_lo:[0,1,0]
    v_pk_mul_f32 v[48:49], v[104:105], v[94:95] op_sel:[0,0] op_sel_hi:[0,1]
    v_pk_fma_f32 v[104:105], v[104:105], v[94:95], v[48:49] op_sel:[1,1,0] op_sel_hi:[1,0,1] neg_lo:[0,1,0]
    v_pk_mul_f32 v[50:51], v[92:93], v[94:95] op_sel:[0,0] op_sel_hi:[0,1]
    v_pk_fma_f32 v[92:93], v[92:93], v[94:95], v[50:51] op_sel:[1,1,0] op_sel_hi:[1,0,1] neg_lo:[0,1,0]
    v_pk_mul_f32 v[52:53], v[106:107], v[94:95] op_sel:[0,0] op_sel_hi:[0,1]
    v_pk_fma_f32 v[106:107], v[106:107], v[94:95], v[52:53] op_sel:[1,1,0] op_sel_hi:[1,0,1] neg_lo:[0,1,0]
    v_pk_mul_f32 v[54:55], v[108:109], v[94:95] op_sel:[0,0] op_sel_hi:[0,1]
    v_pk_fma_f32 v[108:109], v[108:109], v[94:95], v[54:55] op_sel:[1,1,0] op_sel_hi:[1,0,1] neg_lo:[0,1,0]
    v_pk_mul_f32 v[48:49], v[110:111], v[94:95] op_sel:[0,0] op_sel_hi:[0,1]
    v_pk_fma_f32 v[110:111], v[110:111], v[94:95], v[48:49] op_sel:[1,1,0] op_sel_hi:[1,0,1] neg_lo:[0,1,0]
    v_cvt_pk_f16_f32 v72, v94, v90
    v_cvt_pk_f16_f32 v73, v84, v104
    v_cvt_pk_f16_f32 v74, v92, v106
    v_cvt_pk_f16_f32 v75, v108, v110
    ds_write_b128 v35, v[72:75] offset:10240
    v_cvt_pk_f16_f32 v76, -v95, -v91
    v_cvt_pk_f16_f32 v77, -v85, -v105
    v_cvt_pk_f16_f32 v78, -v93, -v107
    v_cvt_pk_f16_f32 v79, -v109, -v111
    ds_write_b128 v35, v[76:79] offset:11264
    buffer_load_dwordx4 v4, s[60:63], s64 offen offset:2048 lds
    s_branch L_kjoin_6
L_partB_5:
    v_ldexp_f32 v56, v28, 1
    v_ldexp_f32 v60, v28, 7
    v_ldexp_f32 v57, v30, 1
    v_ldexp_f32 v61, v30, 7
    v_ldexp_f32 v58, v31, 1
    v_ldexp_f32 v62, v31, 7
    v_exp_f32 v56, v56
    v_exp_f32 v60, v60
    v_fract_f32 v57, v57
    v_fract_f32 v61, v61
    v_add_f32 v57, v57, v58
    v_add_f32 v61, v61, v62
    v_cos_f32 v82, v57
    v_cos_f32 v84, v61
    v_sin_f32 v83, v57
    v_sin_f32 v85, v61
    v_mul_f32 v82, v56, v82
    v_mul_f32 v84, v60, v84
    v_mul_f32 v83, v56, v83
    v_mul_f32 v85, v60, v85
    s_add_u32 m0, s70, 4096
    s_nop 0
    buffer_load_dwordx4 v2, s[60:63], s64 offen offset:0 lds
    v_pk_mul_f32 v[50:51], v[82:83], v[82:83] op_sel:[0,0] op_sel_hi:[0,1]
    v_pk_fma_f32 v[86:87], v[82:83], v[82:83], v[50:51] op_sel:[1,1,0] op_sel_hi:[1,0,1] neg_lo:[0,1,0]
    v_pk_mul_f32 v[52:53], v[84:85], v[84:85] op_sel:[0,0] op_sel_hi:[0,1]
    v_pk_fma_f32 v[88:89], v[84:85], v[84:85], v[52:53] op_sel:[1,1,0] op_sel_hi:[1,0,1] neg_lo:[0,1,0]
    v_pk_mul_f32 v[54:55], v[80:81], v[82:83] op_sel:[0,0] op_sel_hi:[0,1]
    v_pk_fma_f32 v[90:91], v[80:81], v[82:83], v[54:55] op_sel:[1,1,0] op_sel_hi:[1,0,1] neg_lo:[0,1,0]
    v_pk_mul_f32 v[48:49], v[88:89], v[88:89] op_sel:[0,0] op_sel_hi:[0,1]
    v_pk_fma_f32 v[92:93], v[88:89], v[88:89], v[48:49] op_sel:[1,1,0] op_sel_hi:[1,0,1] neg_lo:[0,1,0]
    v_pk_mul_f32 v[50:51], v[80:81], v[86:87] op_sel:[0,0] op_sel_hi:[0,1]
    v_pk_fma_f32 v[94:95], v[80:81], v[86:87], v[50:51] op_sel:[1,1,0] op_sel_hi:[1,0,1] neg_lo:[0,1,0]
    v_pk_mul_f32 v[52:53], v[90:91], v[86:87] op_sel:[0,0] op_sel_hi:[0,1]
    v_pk_fma_f32 v[96:97], v[90:91], v[86:87], v[52:53] op_sel:[1,1,0] op_sel_hi:[1,0,1] neg_lo:[0,1,0]
    v_pk_mul_f32 v[54:55], v[92:93], v[92:93] op_sel:[0,0] op_sel_hi:[0,1]
    v_pk_fma_f32 v[98:99], v[92:93], v[92:93], v[54:55] op_sel:[1,1,0] op_sel_hi:[1,0,1] neg_lo:[0,1,0]
    v_pk_mul_f32 v[48:49], v[80:81], v[84:85] op_sel:[0,0] op_sel_hi:[0,1]
    v_pk_fma_f32 v[100:101], v[80:81], v[84:85], v[48:49] op_sel:[1,1,0] op_sel_hi:[1,0,1] neg_lo:[0,1,0]
    v_pk_mul_f32 v[50:51], v[90:91], v[84:85] op_sel:[0,0] op_sel_hi:[0,1]
    v_pk_fma_f32 v[102:103], v[90:91], v[84:85], v[50:51] op_sel:[1,1,0] op_sel_hi:[1,0,1] neg_lo:[0,1,0]
    v_pk_mul_f32 v[52:53], v[94:95], v[84:85] op_sel:[0,0] op_sel_hi:[0,1]
    v_pk_fma_f32 v[104:105], v[94:95], v[84:85], v[52:53] op_sel:[1,1,0] op_sel_hi:[1,0,1] neg_lo:[0,1,0]
    v_pk_mul_f32 v[54:55], v[96:97], v[84:85] op_sel:[0,0] op_sel_hi:[0,1]
    v_pk_fma_f32 v[106:107], v[96:97], v[84:85], v[54:55] op_sel:[1,1,0] op_sel_hi:[1,0,1] neg_lo:[0,1,0]
    v_pk_mul_f32 v[48:49], v[80:81], v[88:89] op_sel:[0,0] op_sel_hi:[0,1]
    v_pk_fma_f32 v[108:109], v[80:81], v[88:89], v[48:49] op_sel:[1,1,0] op_sel_hi:[1,0,1] neg_lo:[0,1,0]
    v_pk_mul_f32 v[50:51], v[90:91], v[88:89] op_sel:[0,0] op_sel_hi:[0,1]
    v_pk_fma_f32 v[110:111], v[90:91], v[88:89], v[50:51] op_sel:[1,1,0] op_sel_hi:[1,0,1] neg_lo:[0,1,0]
    v_pk_mul_f32 v[52:53], v[94:95], v[88:89] op_sel:[0,0] op_sel_hi:[0,1]
    v_pk_fma_f32 v[112:113], v[94:95], v[88:89], v[52:53] op_sel:[1,1,0] op_sel_hi:[1,0,1] neg_lo:[0,1,0]
    v_pk_mul_f32 v[54:55], v[96:97], v[88:89] op_sel:[0,0] op_sel_hi:[0,1]
    v_pk_fma_f32 v[114:115], v[96:97], v[88:89], v[54:55] op_sel:[1,1,0] op_sel_hi:[1,0,1] neg_lo:[0,1,0]
    v_pk_mul_f32 v[48:49], v[100:101], v[88:89] op_sel:[0,0] op_sel_hi:[0,1]
    v_pk_fma_f32 v[116:117], v[100:101], v[88:89], v[48:49] op_sel:[1,1,0] op_sel_hi:[1,0,1] neg_lo:[0,1,0]
    v_pk_mul_f32 v[50:51], v[102:103], v[88:89] op_sel:[0,0] op_sel_hi:[0,1]
    v_pk_fma_f32 v[118:119], v[102:103], v[88:89], v[50:51] op_sel:[1,1,0] op_sel_hi:[1,0,1] neg_lo:[0,1,0]
    v_pk_mul_f32 v[52:53], v[104:105], v[88:89] op_sel:[0,0] op_sel_hi:[0,1]
    v_pk_fma_f32 v[120:121], v[104:105], v[88:89], v[52:53] op_sel:[1,1,0] op_sel_hi:[1,0,1] neg_lo:[0,1,0]
    v_pk_mul_f32 v[54:55], v[106:107], v[88:89] op_sel:[0,0] op_sel_hi:[0,1]
    v_pk_fma_f32 v[122:123], v[106:107], v[88:89], v[54:55] op_sel:[1,1,0] op_sel_hi:[1,0,1] neg_lo:[0,1,0]
    v_cvt_pk_f16_f32 v64, v108, v110
    v_cvt_pk_f16_f32 v65, v112, v114
    v_cvt_pk_f16_f32 v66, v116, v118
    v_cvt_pk_f16_f32 v67, v120, v122
    ds_write_b128 v35, v[64:67] offset:8192
    v_cvt_pk_f16_f32 v68, v109, v111
    v_cvt_pk_f16_f32 v69, v113, v115
    v_cvt_pk_f16_f32 v70, v117, v119
    v_cvt_pk_f16_f32 v71, v121, v123
    ds_write_b128 v35, v[68:71] offset:9216
    v_pk_mul_f32 v[48:49], v[80:81], v[92:93] op_sel:[0,0] op_sel_hi:[0,1]
    v_pk_fma_f32 v[124:125], v[80:81], v[92:93], v[48:49] op_sel:[1,1,0] op_sel_hi:[1,0,1] neg_lo:[0,1,0]
    v_pk_mul_f32 v[50:51], v[94:95], v[92:93] op_sel:[0,0] op_sel_hi:[0,1]
    v_pk_fma_f32 v[126:127], v[94:95], v[92:93], v[50:51] op_sel:[1,1,0] op_sel_hi:[1,0,1] neg_lo:[0,1,0]
    v_pk_mul_f32 v[52:53], v[100:101], v[92:93] op_sel:[0,0] op_sel_hi:[0,1]
    v_pk_fma_f32 v[38:39], v[100:101], v[92:93], v[52:53] op_sel:[1,1,0] op_sel_hi:[1,0,1] neg_lo:[0,1,0]
    v_pk_mul_f32 v[54:55], v[104:105], v[92:93] op_sel:[0,0] op_sel_hi:[0,1]
    v_pk_fma_f32 v[40:41], v[104:105], v[92:93], v[54:55] op_sel:[1,1,0] op_sel_hi:[1,0,1] neg_lo:[0,1,0]
    v_pk_mul_f32 v[48:49], v[108:109], v[92:93] op_sel:[0,0] op_sel_hi:[0,1]
    v_pk_fma_f32 v[42:43], v[108:109], v[92:93], v[48:49] op_sel:[1,1,0] op_sel_hi:[1,0,1] neg_lo:[0,1,0]
    v_pk_mul_f32 v[50:51], v[112:113], v[92:93] op_sel:[0,0] op_sel_hi:[0,1]
    v_pk_fma_f32 v[44:45], v[112:113], v[92:93], v[50:51] op_sel:[1,1,0] op_sel_hi:[1,0,1] neg_lo:[0,1,0]
    buffer_load_dwordx4 v3, s[60:63], s64 offen offset:1024 lds
    v_pk_mul_f32 v[52:53], v[116:117], v[92:93] op_sel:[0,0] op_sel_hi:[0,1]
    v_pk_fma_f32 v[46:47], v[116:117], v[92:93], v[52:53] op_sel:[1,1,0] op_sel_hi:[1,0,1] neg_lo:[0,1,0]
    v_pk_mul_f32 v[54:55], v[120:121], v[92:93] op_sel:[0,0] op_sel_hi:[0,1]
    v_pk_fma_f32 v[24:25], v[120:121], v[92:93], v[54:55] op_sel:[1,1,0] op_sel_hi:[1,0,1] neg_lo:[0,1,0]
    v_cvt_pk_f16_f32 v72, v124, v126
    v_cvt_pk_f16_f32 v73, v38, v40
    v_cvt_pk_f16_f32 v74, v42, v44
    v_cvt_pk_f16_f32 v75, v46, v24
    ds_write_b128 v35, v[72:75] offset:10240
    v_cvt_pk_f16_f32 v76, v125, v127
    v_cvt_pk_f16_f32 v77, v39, v41
    v_cvt_pk_f16_f32 v78, v43, v45
    v_cvt_pk_f16_f32 v79, v47, v25
    ds_write_b128 v35, v[76:79] offset:11264
    v_pk_mul_f32 v[48:49], v[80:81], v[98:99] op_sel:[0,0] op_sel_hi:[0,1]
    v_pk_fma_f32 v[80:81], v[80:81], v[98:99], v[48:49] op_sel:[1,1,0] op_sel_hi:[1,0,1] neg_lo:[0,1,0]
    v_pk_mul_f32 v[50:51], v[100:101], v[98:99] op_sel:[0,0] op_sel_hi:[0,1]
    v_pk_fma_f32 v[100:101], v[100:101], v[98:99], v[50:51] op_sel:[1,1,0] op_sel_hi:[1,0,1] neg_lo:[0,1,0]
    v_pk_mul_f32 v[52:53], v[108:109], v[98:99] op_sel:[0,0] op_sel_hi:[0,1]
    v_pk_fma_f32 v[108:109], v[108:109], v[98:99], v[52:53] op_sel:[1,1,0] op_sel_hi:[1,0,1] neg_lo:[0,1,0]
    v_pk_mul_f32 v[54:55], v[116:117], v[98:99] op_sel:[0,0] op_sel_hi:[0,1]
    v_pk_fma_f32 v[116:117], v[116:117], v[98:99], v[54:55] op_sel:[1,1,0] op_sel_hi:[1,0,1] neg_lo:[0,1,0]
    v_pk_mul_f32 v[48:49], v[124:125], v[98:99] op_sel:[0,0] op_sel_hi:[0,1]
    v_pk_fma_f32 v[124:125], v[124:125], v[98:99], v[48:49] op_sel:[1,1,0] op_sel_hi:[1,0,1] neg_lo:[0,1,0]
    v_pk_mul_f32 v[50:51], v[38:39], v[98:99] op_sel:[0,0] op_sel_hi:[0,1]
    v_pk_fma_f32 v[38:39], v[38:39], v[98:99], v[50:51] op_sel:[1,1,0] op_sel_hi:[1,0,1] neg_lo:[0,1,0]
    v_pk_mul_f32 v[52:53], v[42:43], v[98:99] op_sel:[0,0] op_sel_hi:[0,1]
    v_pk_fma_f32 v[42:43], v[42:43], v[98:99], v[52:53] op_sel:[1,1,0] op_sel_hi:[1,0,1] neg_lo:[0,1,0]
    v_pk_mul_f32 v[54:55], v[46:47], v[98:99] op_sel:[0,0] op_sel_hi:[0,1]
    v_pk_fma_f32 v[46:47], v[46:47], v[98:99], v[54:55] op_sel:[1,1,0] op_sel_hi:[1,0,1] neg_lo:[0,1,0]
    v_cvt_pk_f16_f32 v64, v80, v100
    v_cvt_pk_f16_f32 v65, v108, v116
    v_cvt_pk_f16_f32 v66, v124, v38
    v_cvt_pk_f16_f32 v67, v42, v46
    ds_write_b128 v35, v[64:67] offset:12288
    v_cvt_pk_f16_f32 v68, v81, v101
    v_cvt_pk_f16_f32 v69, v109, v117
    v_cvt_pk_f16_f32 v70, v125, v39
    v_cvt_pk_f16_f32 v71, v43, v47
    ds_write_b128 v35, v[68:71] offset:13312
    v_pk_mul_f32 v[48:49], v[80:81], v[98:99] op_sel:[0,0] op_sel_hi:[0,1]
    v_pk_fma_f32 v[82:83], v[80:81], v[98:99], v[48:49] op_sel:[1,1,0] op_sel_hi:[1,0,1] neg_lo:[0,1,0]
    v_cvt_pk_f16_f32 v86, v82, v82
    v_cvt_pk_f16_f32 v87, v83, v83
    ds_write_b32 v35, v86 offset:14336
    ds_write_b32 v35, v87 offset:15360
    buffer_load_dwordx4 v4, s[60:63], s64 offen offset:2048 lds
L_kjoin_6:
    s_cmp_lg_u32 s3, 3
    s_cbranch_scc1 L_noz_7
    global_load_dword v14, v12, s[46:47] sc1
L_noz_7:
    buffer_load_dwordx4 v5, s[60:63], s64 offen offset:3072 lds
    s_add_u32 s64, s64, 114688
    s_cmp_eq_u32 s64, s65
    s_cselect_b32 s64, s66, s64
    buffer_load_dwordx4 v[160:163], v2, s[60:63], s64 offen offset:0
    v_lshrrev_b32 v80, 4, v0
    v_bfe_u32 v81, v0, 2, 2
    v_lshl_add_u32 v80, v80, 2, v81
    v_lshlrev_b32 v80, 4, v80
    v_bfe_u32 v81, v0, 1, 1
    v_lshl_add_u32 v80, v81, 11, v80
    v_and_b32 v81, 1, v0
    v_lshl_add_u32 v80, v81, 3, v80
    s_lshl_b32 s12, s8, 16
    s_and_b32 s14, s3, 3
    s_add_u32 s12, s12, 8192
    v_add_u32 v80, s12, v80
    s_mov_b32 s12, 4096
    s_cmp_eq_u32 s14, 1
    s_cselect_b32 s12, 16384, s12
    s_cmp_eq_u32 s14, 2
    s_cselect_b32 s12, 20480, s12
    v_add_u32 v81, s12, v80
    s_waitcnt vmcnt(6)
    s_waitcnt vmcnt(5)
    v_lshlrev_b32 v82, 10, v0
    v_mov_b32 v83, 1
    s_waitcnt lgkmcnt(0)
    s_barrier
    s_cmp_lg_u32 s3, 3
    s_cbranch_scc1 L_noflag_8
    s_waitcnt vmcnt(9)
    v_cmp_ne_u32 vcc, 1, v13
    s_cbranch_vccz L_guard_9
    s_waitcnt vmcnt(2)
    v_cmp_ne_u32 vcc, 1, v14
    s_cbranch_vccz L_guard_9
    s_mov_b32 s82, 0
L_gspin_10:
    global_load_dword v13, v12, s[46:47] sc1
    s_waitcnt vmcnt(0)
    v_cmp_ne_u32 vcc, 1, v13
    s_add_u32 s82, s82, 1
    s_cbranch_vccz L_guard_9
    s_sleep 2
    s_cmp_lt_u32 s82, 65536
    s_cbranch_scc1 L_gspin_10
L_guard_9:
    s_sub_u32 s80, s80, 3072
    s_mov_b64 exec, 0xff
    buffer_store_dword v83, v82, s[56:59], s80 offen sc1
    s_mov_b64 exec, -1
L_noflag_8:
    s_cmp_eq_u32 s14, 3
    s_cbranch_scc1 L_tdone_11
    ds_read_b64_tr_b16 v[16:17], v80 offset:0
    ds_read_b64_tr_b16 v[48:49], v81 offset:0
    ds_read_b64_tr_b16 v[18:19], v80 offset:256
    ds_read_b64_tr_b16 v[50:51], v81 offset:256
    ds_read_b64_tr_b16 v[20:21], v80 offset:512
    ds_read_b64_tr_b16 v[52:53], v81 offset:512
    ds_read_b64_tr_b16 v[22:23], v80 offset:768
    ds_read_b64_tr_b16 v[54:55], v81 offset:768
    ds_read_b64_tr_b16 v[24:25], v80 offset:1024
    ds_read_b64_tr_b16 v[56:57], v81 offset:1024
    ds_read_b64_tr_b16 v[26:27], v80 offset:1280
    ds_read_b64_tr_b16 v[58:59], v81 offset:1280
    ds_read_b64_tr_b16 v[28:29], v80 offset:1536
    ds_read_b64_tr_b16 v[60:61], v81 offset:1536
    ds_read_b64_tr_b16 v[30:31], v80 offset:1792
    ds_read_b64_tr_b16 v[62:63], v81 offset:1792
    ds_read_b64_tr_b16 v[32:33], v80 offset:32768
    ds_read_b64_tr_b16 v[64:65], v81 offset:32768
    ds_read_b64_tr_b16 v[34:35], v80 offset:33024
    ds_read_b64_tr_b16 v[66:67], v81 offset:33024
    ds_read_b64_tr_b16 v[36:37], v80 offset:33280
    ds_read_b64_tr_b16 v[68:69], v81 offset:33280
    ds_read_b64_tr_b16 v[38:39], v80 offset:33536
    ds_read_b64_tr_b16 v[70:71], v81 offset:33536
    ds_read_b64_tr_b16 v[40:41], v80 offset:33792
    ds_read_b64_tr_b16 v[72:73], v81 offset:33792
    ds_read_b64_tr_b16 v[42:43], v80 offset:34048
    ds_read_b64_tr_b16 v[74:75], v81 offset:34048
    ds_read_b64_tr_b16 v[44:45], v80 offset:34304
    ds_read_b64_tr_b16 v[76:77], v81 offset:34304
    ds_read_b64_tr_b16 v[46:47], v80 offset:34560
    ds_read_b64_tr_b16 v[78:79], v81 offset:34560
    v_and_b32 v84, 15, v0
    v_lshrrev_b32 v85, 4, v0
    s_lshl_b32 s12, s8, 11
    s_add_u32 s12, s12, 157696
    s_waitcnt lgkmcnt(15)
    v_mfma_f32_16x16x32_f16 v[88:91], v[48:51], v[16:19], 0
    s_waitcnt lgkmcnt(15)
    v_mfma_f32_16x16x32_f16 v[88:91], v[52:55], v[20:23], v[88:91]
    s_waitcnt lgkmcnt(15)
    v_mfma_f32_16x16x32_f16 v[88:91], v[56:59], v[24:27], v[88:91]
    s_waitcnt lgkmcnt(15)
    v_mfma_f32_16x16x32_f16 v[88:91], v[60:63], v[28:31], v[88:91]
    s_waitcnt lgkmcnt(12)
    v_mfma_f32_16x16x32_f16 v[92:95], v[64:67], v[32:35], 0
    s_waitcnt lgkmcnt(8)
    v_mfma_f32_16x16x32_f16 v[92:95], v[68:71], v[36:39], v[92:95]
    s_waitcnt lgkmcnt(4)
    v_mfma_f32_16x16x32_f16 v[92:95], v[72:75], v[40:43], v[92:95]
    s_waitcnt lgkmcnt(0)
    v_mfma_f32_16x16x32_f16 v[92:95], v[76:79], v[44:47], v[92:95]
    s_cmp_eq_u32 s14, 1
    s_cbranch_scc1 L_t1_12
    s_cmp_eq_u32 s14, 2
    s_cbranch_scc1 L_t2_13
    v_lshlrev_b32 v86, 4, v84
    v_and_b32 v87, 1, v85
    v_lshl_add_u32 v86, v87, 3, v86
    v_lshrrev_b32 v87, 1, v85
    v_lshl_add_u32 v86, v87, 8, v86
    v_add_u32 v86, s12, v86
    v_pk_add_f32 v[88:89], v[88:89], v[92:93]
    v_pk_add_f32 v[90:91], v[90:91], v[94:95]
    v_cvt_pk_f16_f32 v88, v88, v89
    v_cvt_pk_f16_f32 v89, v90, v91
    ds_write_b64 v86, v[88:89]
    s_branch L_tdone_11
L_t1_12:
    v_lshlrev_b32 v86, 7, v85
    v_lshl_add_u32 v87, v84, 3, v86
    v_lshl_add_u32 v86, v84, 2, v86
    v_cmp_gt_u32 vcc, 2, v85
    s_nop 1
    v_cndmask_b32 v86, v86, v87, vcc
    v_mov_b32 v87, 4
    v_cndmask_b32 v87, 64, v87, vcc
    v_add_u32 v86, s12, v86
    v_add_u32 v87, v86, v87
    v_pk_add_f32 v[88:89], v[88:89], v[92:93]
    v_pk_add_f32 v[90:91], v[90:91], v[94:95]
    v_cvt_pk_f16_f32 v88, v88, v89
    v_cvt_pk_f16_f32 v89, v90, v91
    ds_write_b32 v86, v88 offset:512
    ds_write_b32 v87, v89 offset:512
    s_branch L_tdone_11
L_t2_13:
    v_lshlrev_b32 v86, 8, v85
    v_lshl_add_u32 v86, v84, 2, v86
    v_add_u32 v86, s12, v86
    s_nop 0
    v_pk_add_f32 v[88:89], v[88:89], v[92:93]
    v_pk_add_f32 v[90:91], v[90:91], v[94:95]
    v_cvt_pk_f16_f32 v88, v88, v88
    v_cvt_pk_f16_f32 v89, v89, v89
    v_cvt_pk_f16_f32 v90, v90, v90
    v_cvt_pk_f16_f32 v91, v91, v91
    ds_write_b32 v86, v88 offset:1024
    ds_write_b32 v86, v89 offset:1088
    ds_write_b32 v86, v90 offset:1152
    ds_write_b32 v86, v91 offset:1216
L_tdone_11:
    buffer_load_dwordx4 v[164:167], v3, s[60:63], s64 offen offset:1024
    buffer_load_dwordx4 v[168:171], v4, s[60:63], s64 offen offset:2048
    buffer_load_dwordx4 v[172:175], v5, s[60:63], s64 offen offset:3072
    s_add_u32 s64, s64, 114688
    s_cmp_eq_u32 s64, s65
    s_cselect_b32 s64, s66, s64
    buffer_load_dwordx4 v[176:179], v2, s[60:63], s64 offen offset:0
    buffer_load_dwordx4 v[180:183], v3, s[60:63], s64 offen offset:1024
    buffer_load_dwordx4 v[184:187], v4, s[60:63], s64 offen offset:2048
    buffer_load_dwordx4 v[188:191], v5, s[60:63], s64 offen offset:3072
    s_add_u32 s64, s64, 114688
    s_cmp_eq_u32 s64, s65
    s_cselect_b32 s64, s66, s64
    buffer_load_dwordx4 v[192:195], v2, s[60:63], s64 offen offset:0
    buffer_load_dwordx4 v[196:199], v3, s[60:63], s64 offen offset:1024
    buffer_load_dwordx4 v[200:203], v4, s[60:63], s64 offen offset:2048
    buffer_load_dwordx4 v[204:207], v5, s[60:63], s64 offen offset:3072
    s_add_u32 s64, s64, 114688
    s_cmp_eq_u32 s64, s65
    s_cselect_b32 s64, s66, s64
    v_mov_b32 v16, 0
    v_mov_b32 v17, 0
    v_mov_b32 v18, 0
    v_mov_b32 v19, 0
    s_mul_i32 s12, s8, 4608
    s_add_u32 s20, s12, 148480
    s_mul_i32 s21, s8, 8320
    s_add_u32 s21, s21, 131072
    s_add_u32 s12, s20, 4128
    v_add_u32 v20, s12, v1
    s_sub_u32 s12, s21, 480
    v_add_u32 v21, s12, v1
    v_cmp_gt_u32 vcc, 30, v0
    s_nop 1
    v_cndmask_b32 v20, v21, v20, vcc
    s_add_u32 s12, s21, 4160
    v_and_b32 v21, 1, v0
    v_lshl_add_u32 v21, v21, 4, s12
    v_cmp_gt_u32 vcc, 32, v0
    s_nop 1
    v_cndmask_b32 v20, v21, v20, vcc
    ds_write_b128 v20, v[16:19]
    s_lshl_b32 s12, s8, 11
    s_add_u32 s12, s12, 157696
    s_lshl_b32 s24, s14, 10
    s_add_u32 s24, s24, s20
    v_add_u32 v20, s24, v1
    v_sub_u32 v21, 63, v0
    buffer_load_dwordx4 v[208:211], v2, s[60:63], s64 offen offset:0
    buffer_load_dwordx4 v[212:215], v3, s[60:63], s64 offen offset:1024
    buffer_load_dwordx4 v[216:219], v4, s[60:63], s64 offen offset:2048
    ds_read_b64_tr_b16 v[128:129], v6 offset:0
    ds_read_b64_tr_b16 v[130:131], v6 offset:512
    ds_read_b64_tr_b16 v[132:133], v7 offset:0
    ds_read_b64_tr_b16 v[134:135], v7 offset:512
    ds_read_b64_tr_b16 v[136:137], v6 offset:2048
    ds_read_b64_tr_b16 v[138:139], v6 offset:2560
    ds_read_b64_tr_b16 v[140:141], v7 offset:2048
    ds_read_b64_tr_b16 v[142:143], v7 offset:2560
    s_waitcnt vmcnt(15)
    ds_read_b64_tr_b16 v[144:145], v6 offset:4096
    ds_read_b64_tr_b16 v[146:147], v6 offset:4608
    ds_read_b64_tr_b16 v[148:149], v7 offset:4096
    ds_read_b64_tr_b16 v[150:151], v7 offset:4608
    ds_read_b64_tr_b16 v[152:153], v6 offset:6144
    ds_read_b64_tr_b16 v[154:155], v6 offset:6656
    ds_read_b64_tr_b16 v[156:157], v7 offset:6144
    ds_read_b64_tr_b16 v[158:159], v7 offset:6656
    s_cmp_lg_u32 s8, 0
    s_cbranch_scc1 L_noxpre
    s_waitcnt vmcnt(11)
    ds_write_b128 v15, v[160:163] offset:0
    ds_write_b128 v15, v[164:167] offset:1024
    ds_write_b128 v15, v[168:171] offset:2048
    ds_write_b128 v15, v[172:175] offset:3072
    ds_read_b64_tr_b16 v[160:161], v6 offset:0
    ds_read_b64_tr_b16 v[162:163], v6 offset:512
    ds_read_b64_tr_b16 v[164:165], v7 offset:0
    ds_read_b64_tr_b16 v[166:167], v7 offset:512
    ds_read_b64_tr_b16 v[168:169], v6 offset:2048
    ds_read_b64_tr_b16 v[170:171], v6 offset:2560
    ds_read_b64_tr_b16 v[172:173], v7 offset:2048
    ds_read_b64_tr_b16 v[174:175], v7 offset:2560
    s_waitcnt vmcnt(7)
    ds_write_b128 v15, v[176:179] offset:4096
    ds_write_b128 v15, v[180:183] offset:5120
    ds_write_b128 v15, v[184:187] offset:6144
    ds_write_b128 v15, v[188:191] offset:7168
    ds_read_b64_tr_b16 v[176:177], v6 offset:4096
    ds_read_b64_tr_b16 v[178:179], v6 offset:4608
    ds_read_b64_tr_b16 v[180:181], v7 offset:4096
    ds_read_b64_tr_b16 v[182:183], v7 offset:4608
    ds_read_b64_tr_b16 v[184:185], v6 offset:6144
    ds_read_b64_tr_b16 v[186:187], v6 offset:6656
    ds_read_b64_tr_b16 v[188:189], v7 offset:6144
    ds_read_b64_tr_b16 v[190:191], v7 offset:6656
L_noxpre:
    s_waitcnt lgkmcnt(0)
    s_barrier
    buffer_load_dwordx4 v[220:223], v5, s[60:63], s64 offen offset:3072
    s_add_u32 s64, s64, 114688
    s_cmp_eq_u32 s64, s65
    s_cselect_b32 s64, s66, s64
    buffer_load_dwordx4 v[224:227], v2, s[60:63], s64 offen offset:0
    buffer_load_dwordx4 v[228:231], v3, s[60:63], s64 offen offset:1024
    buffer_load_dwordx4 v[232:235], v4, s[60:63], s64 offen offset:2048
    buffer_load_dwordx4 v[236:239], v5, s[60:63], s64 offen offset:3072
    s_add_u32 s64, s64, 114688
    s_cmp_eq_u32 s64, s65
    s_cselect_b32 s64, s66, s64
    s_cmp_eq_u32 s14, 2
    s_cbranch_scc1 L_e2_14
    s_cmp_eq_u32 s14, 3
    s_cbranch_scc1 L_e3_15
    s_xor_b32 s24, s14, 1
    s_lshl_b32 s24, s24, 8
    s_add_u32 s24, s24, s12
    v_lshl_add_u32 v24, v21, 2, s24
    v_add_u32 v24, 1024, v24
    ds_read2_b32 v[26:27], v24 offset0:0 offset1:1
    v_and_b32 v25, 1, v21
    v_cmp_eq_u32 vcc, 0, v25
    s_waitcnt lgkmcnt(0)
    v_mov_b32 v16, v27
    v_cndmask_b32 v25, v27, v26, vcc
    s_mov_b32 s24, 0xffff
    v_bfi_b32 v17, s24, v27, v25
    v_mov_b32 v18, v26
    v_mov_b32 v19, v26
    s_branch L_ej_16
L_e2_14:
    v_lshl_add_u32 v24, v21, 2, s12
    ds_read2_b32 v[26:27], v24 offset0:192 offset1:193
    s_mov_b32 s24, 0x01000100
    s_mov_b32 s25, 0x03020302
    s_mov_b32 s26, 0x01000302
    s_waitcnt lgkmcnt(0)
    v_perm_b32 v16, v27, v27, s24
    v_perm_b32 v17, v26, v26, s25
    v_perm_b32 v18, v26, v26, s26
    v_perm_b32 v19, v26, v26, s24
    s_branch L_ej_16
L_e3_15:
    v_lshlrev_b32 v24, 4, v21
    v_lshlrev_b32 v25, 3, v21
    v_add_u32 v25, 252, v25
    v_cmp_gt_u32 vcc, 32, v21
    s_nop 1
    v_cndmask_b32 v24, v25, v24, vcc
    v_add_u32 v24, s12, v24
    ds_read2_b32 v[26:27], v24 offset0:0 offset1:1
    ds_read2_b32 v[28:29], v24 offset0:2 offset1:3
    v_mov_b32 v30, 0x05040706
    v_mov_b32 v31, 0x01000302
    v_mov_b32 v32, 0x01000302
    v_mov_b32 v33, 0x01000302
    s_mov_b32 exec_hi, 0
    v_mov_b32 v30, 0x03020504
    v_mov_b32 v31, 0x01000100
    v_mov_b32 v32, 0x03020504
    v_mov_b32 v33, 0x05040504
    s_mov_b64 exec, -1
    s_waitcnt lgkmcnt(0)
    v_perm_b32 v16, v29, v28, v30
    v_perm_b32 v17, v28, v28, v31
    v_perm_b32 v18, v28, v27, v32
    v_perm_b32 v19, v27, v26, v33
L_ej_16:
    ds_write_b128 v20, v[16:19] offset:32
    v_lshrrev_b32 v16, 1, v0
    v_and_b32 v17, 1, v0
    v_lshlrev_b32 v18, 9, v16
    v_lshl_add_u32 v18, v17, 4, v18
    s_lshr_b32 s24, s7, 4
    s_lshl_b32 s24, s24, 17
    s_and_b32 s25, s7, 15
    s_lshl_b32 s25, s25, 5
    s_add_u32 s24, s24, s25
    s_add_u32 s24, s24, s70
    s_add_u32 s24, s24, 0x200000
    v_mul_u32_u24 v19, 8320, v17
    v_lshl_add_u32 v19, v16, 4, v19
    s_lshl_b32 s25, s3, 9
    s_add_u32 s25, s25, 131104
    v_add_u32 v19, s25, v19
    s_lshl_b32 s25, s3, 7
    s_lshl_b32 s26, s50, 10
    s_add_u32 s26, s26, s25
    s_add_u32 s26, s26, 0xc00000
    s_lshl_b32 s27, s5, 10
    s_add_u32 s27, s27, s25
    s_add_u32 s27, s27, 0xc00000
    s_cmp_eq_u32 s15, 7
    s_cbranch_scc1 L_gx
    buffer_load_dwordx4 v[240:243], v2, s[60:63], s64 offen offset:0
    buffer_load_dwordx4 v[244:247], v3, s[60:63], s64 offen offset:1024
    buffer_load_dwordx4 v[248:251], v4, s[60:63], s64 offen offset:2048
    buffer_load_dwordx4 v[252:255], v5, s[60:63], s64 offen offset:3072
    s_add_u32 s64, s64, 114688
    s_cmp_eq_u32 s64, s65
    s_cselect_b32 s64, s66, s64
    v_mov_b32 v8, v18
    v_mov_b32 v9, v19
    s_cmp_lg_u32 s8, 0
    s_cbranch_scc1 L_yseg
    buffer_load_dword v16, v10, s[56:59], s26 offen sc1
    s_waitcnt vmcnt(13)
    ds_write_b128 v15, v[192:195] offset:0
    ds_write_b128 v15, v[196:199] offset:1024
    ds_write_b128 v15, v[200:203] offset:2048
    ds_write_b128 v15, v[204:207] offset:3072
    ds_read_b64_tr_b16 v[192:193], v6 offset:0
    ds_read_b64_tr_b16 v[194:195], v6 offset:512
    ds_read_b64_tr_b16 v[196:197], v7 offset:0
    ds_read_b64_tr_b16 v[198:199], v7 offset:512
    ds_read_b64_tr_b16 v[200:201], v6 offset:2048
    ds_read_b64_tr_b16 v[202:203], v6 offset:2560
    ds_read_b64_tr_b16 v[204:205], v7 offset:2048
    ds_read_b64_tr_b16 v[206:207], v7 offset:2560
    s_waitcnt vmcnt(9)
    ds_write_b128 v15, v[208:211] offset:4096
    ds_write_b128 v15, v[212:215] offset:5120
    ds_write_b128 v15, v[216:219] offset:6144
    ds_write_b128 v15, v[220:223] offset:7168
    ds_read_b64_tr_b16 v[208:209], v6 offset:4096
    ds_read_b64_tr_b16 v[210:211], v6 offset:4608
    ds_read_b64_tr_b16 v[212:213], v7 offset:4096
    ds_read_b64_tr_b16 v[214:215], v7 offset:4608
    ds_read_b64_tr_b16 v[216:217], v6 offset:6144
    ds_read_b64_tr_b16 v[218:219], v6 offset:6656
    ds_read_b64_tr_b16 v[220:221], v7 offset:6144
    ds_read_b64_tr_b16 v[222:223], v7 offset:6656
    s_waitcnt vmcnt(0)
    v_cmp_ne_u32 vcc, 1, v16
    s_cbranch_vccz L_pcok_17
    s_mov_b32 s82, 0
L_spin_18:
    buffer_load_dword v16, v10, s[56:59], s26 offen sc1
    s_waitcnt vmcnt(0)
    v_cmp_ne_u32 vcc, 1, v16
    s_add_u32 s82, s82, 1
    s_cbranch_vccz L_spind_19
    s_cmp_ge_u32 s82, 65536
    s_cbranch_scc1 L_spind_19
    s_sleep 1
    s_branch L_spin_18
L_spind_19:
L_pcok_17:
    buffer_load_dwordx4 v[80:83], v1, s[56:59], s67 offen offset:0
    buffer_load_dwordx4 v[84:87], v1, s[56:59], s68 offen offset:0
    buffer_load_dwordx4 v[88:91], v1, s[56:59], s67 offen offset:1024
    buffer_load_dwordx4 v[92:95], v1, s[56:59], s68 offen offset:1024
    s_add_u32 s67, s67, 2048
    s_cmp_eq_u32 s67, s69
    s_cselect_b32 s67, s74, s67
    s_add_u32 s68, s67, 131072
    buffer_load_dwordx4 v[96:99], v1, s[56:59], s67 offen offset:0
    buffer_load_dwordx4 v[100:103], v1, s[56:59], s68 offen offset:0
    buffer_load_dwordx4 v[104:107], v1, s[56:59], s67 offen offset:1024
    buffer_load_dwordx4 v[108:111], v1, s[56:59], s68 offen offset:1024
    s_add_u32 s67, s67, 2048
    s_cmp_eq_u32 s67, s69
    s_cselect_b32 s67, s74, s67
    s_add_u32 s68, s67, 131072
    buffer_load_dwordx4 v[112:115], v1, s[56:59], s67 offen offset:0
    buffer_load_dwordx4 v[116:119], v1, s[56:59], s68 offen offset:0
    buffer_load_dwordx4 v[120:123], v1, s[56:59], s67 offen offset:1024
    buffer_load_dwordx4 v[124:127], v1, s[56:59], s68 offen offset:1024
    s_add_u32 s67, s67, 2048
    s_cmp_eq_u32 s67, s69
    s_cselect_b32 s67, s74, s67
    s_add_u32 s68, s67, 131072
    ds_write_b128 v15, v[224:227] offset:0
    ds_write_b128 v15, v[228:231] offset:1024
    ds_write_b128 v15, v[232:235] offset:2048
    ds_write_b128 v15, v[236:239] offset:3072
    ds_read_b64_tr_b16 v[224:225], v6 offset:0
    ds_read_b64_tr_b16 v[226:227], v6 offset:512
    ds_read_b64_tr_b16 v[228:229], v7 offset:0
    ds_read_b64_tr_b16 v[230:231], v7 offset:512
    ds_read_b64_tr_b16 v[232:233], v6 offset:2048
    ds_read_b64_tr_b16 v[234:235], v6 offset:2560
    ds_read_b64_tr_b16 v[236:237], v7 offset:2048
    ds_read_b64_tr_b16 v[238:239], v7 offset:2560
    ds_write_b128 v15, v[240:243] offset:4096
    ds_write_b128 v15, v[244:247] offset:5120
    ds_write_b128 v15, v[248:251] offset:6144
    ds_write_b128 v15, v[252:255] offset:7168
    ds_read_b64_tr_b16 v[240:241], v6 offset:4096
    ds_read_b64_tr_b16 v[242:243], v6 offset:4608
    ds_read_b64_tr_b16 v[244:245], v7 offset:4096
    ds_read_b64_tr_b16 v[246:247], v7 offset:4608
    ds_read_b64_tr_b16 v[248:249], v6 offset:6144
    ds_read_b64_tr_b16 v[250:251], v6 offset:6656
    ds_read_b64_tr_b16 v[252:253], v7 offset:6144
    ds_read_b64_tr_b16 v[254:255], v7 offset:6656
    s_branch L_segj
L_yseg:
    s_waitcnt vmcnt(20)
    ds_write_b128 v15, v[160:163] offset:0
    ds_write_b128 v15, v[164:167] offset:1024
    ds_write_b128 v15, v[168:171] offset:2048
    ds_write_b128 v15, v[172:175] offset:3072
    ds_read_b64_tr_b16 v[160:161], v6 offset:0
    ds_read_b64_tr_b16 v[162:163], v6 offset:512
    ds_read_b64_tr_b16 v[164:165], v7 offset:0
    ds_read_b64_tr_b16 v[166:167], v7 offset:512
    ds_read_b64_tr_b16 v[168:169], v6 offset:2048
    ds_read_b64_tr_b16 v[170:171], v6 offset:2560
    ds_read_b64_tr_b16 v[172:173], v7 offset:2048
    ds_read_b64_tr_b16 v[174:175], v7 offset:2560
    s_waitcnt vmcnt(16)
    ds_write_b128 v15, v[176:179] offset:4096
    ds_write_b128 v15, v[180:183] offset:5120
    ds_write_b128 v15, v[184:187] offset:6144
    ds_write_b128 v15, v[188:191] offset:7168
    ds_read_b64_tr_b16 v[176:177], v6 offset:4096
    ds_read_b64_tr_b16 v[178:179], v6 offset:4608
    ds_read_b64_tr_b16 v[180:181], v7 offset:4096
    ds_read_b64_tr_b16 v[182:183], v7 offset:4608
    ds_read_b64_tr_b16 v[184:185], v6 offset:6144
    ds_read_b64_tr_b16 v[186:187], v6 offset:6656
    ds_read_b64_tr_b16 v[188:189], v7 offset:6144
    ds_read_b64_tr_b16 v[190:191], v7 offset:6656
    s_waitcnt vmcnt(12)
    ds_write_b128 v15, v[192:195] offset:0
    ds_write_b128 v15, v[196:199] offset:1024
    ds_write_b128 v15, v[200:203] offset:2048
    ds_write_b128 v15, v[204:207] offset:3072
    ds_read_b64_tr_b16 v[192:193], v6 offset:0
    ds_read_b64_tr_b16 v[194:195], v6 offset:512
    ds_read_b64_tr_b16 v[196:197], v7 offset:0
    ds_read_b64_tr_b16 v[198:199], v7 offset:512
    ds_read_b64_tr_b16 v[200:201], v6 offset:2048
    ds_read_b64_tr_b16 v[202:203], v6 offset:2560
    ds_read_b64_tr_b16 v[204:205], v7 offset:2048
    ds_read_b64_tr_b16 v[206:207], v7 offset:2560
    s_waitcnt vmcnt(8)
    ds_write_b128 v15, v[208:211] offset:4096
    ds_write_b128 v15, v[212:215] offset:5120
    ds_write_b128 v15, v[216:219] offset:6144
    ds_write_b128 v15, v[220:223] offset:7168
    ds_read_b64_tr_b16 v[208:209], v6 offset:4096
    ds_read_b64_tr_b16 v[210:211], v6 offset:4608
    ds_read_b64_tr_b16 v[212:213], v7 offset:4096
    ds_read_b64_tr_b16 v[214:215], v7 offset:4608
    ds_read_b64_tr_b16 v[216:217], v6 offset:6144
    ds_read_b64_tr_b16 v[218:219], v6 offset:6656
    ds_read_b64_tr_b16 v[220:221], v7 offset:6144
    ds_read_b64_tr_b16 v[222:223], v7 offset:6656
    buffer_load_dword v16, v10, s[56:59], s26 offen sc1
    s_waitcnt vmcnt(5)
    ds_write_b128 v15, v[224:227] offset:0
    ds_write_b128 v15, v[228:231] offset:1024
    ds_write_b128 v15, v[232:235] offset:2048
    ds_write_b128 v15, v[236:239] offset:3072
    ds_read_b64_tr_b16 v[224:225], v6 offset:0
    ds_read_b64_tr_b16 v[226:227], v6 offset:512
    ds_read_b64_tr_b16 v[228:229], v7 offset:0
    ds_read_b64_tr_b16 v[230:231], v7 offset:512
    ds_read_b64_tr_b16 v[232:233], v6 offset:2048
    ds_read_b64_tr_b16 v[234:235], v6 offset:2560
    ds_read_b64_tr_b16 v[236:237], v7 offset:2048
    ds_read_b64_tr_b16 v[238:239], v7 offset:2560
    s_waitcnt vmcnt(1)
    ds_write_b128 v15, v[240:243] offset:4096
    ds_write_b128 v15, v[244:247] offset:5120
    ds_write_b128 v15, v[248:251] offset:6144
    ds_write_b128 v15, v[252:255] offset:7168
    ds_read_b64_tr_b16 v[240:241], v6 offset:4096
    ds_read_b64_tr_b16 v[242:243], v6 offset:4608
    ds_read_b64_tr_b16 v[244:245], v7 offset:4096
    ds_read_b64_tr_b16 v[246:247], v7 offset:4608
    ds_read_b64_tr_b16 v[248:249], v6 offset:6144
    ds_read_b64_tr_b16 v[250:251], v6 offset:6656
    ds_read_b64_tr_b16 v[252:253], v7 offset:6144
    ds_read_b64_tr_b16 v[254:255], v7 offset:6656
    s_waitcnt vmcnt(0)
    v_cmp_ne_u32 vcc, 1, v16
    s_cbranch_vccz L_pcok_20
    s_mov_b32 s82, 0
L_spin_21:
    buffer_load_dword v16, v10, s[56:59], s26 offen sc1
    s_waitcnt vmcnt(0)
    v_cmp_ne_u32 vcc, 1, v16
    s_add_u32 s82, s82, 1
    s_cbranch_vccz L_spind_22
    s_cmp_ge_u32 s82, 65536
    s_cbranch_scc1 L_spind_22
    s_sleep 1
    s_branch L_spin_21
L_spind_22:
L_pcok_20:
    buffer_load_dwordx4 v[80:83], v1, s[56:59], s67 offen offset:0
    buffer_load_dwordx4 v[84:87], v1, s[56:59], s68 offen offset:0
    buffer_load_dwordx4 v[88:91], v1, s[56:59], s67 offen offset:1024
    buffer_load_dwordx4 v[92:95], v1, s[56:59], s68 offen offset:1024
    s_add_u32 s67, s67, 2048
    s_cmp_eq_u32 s67, s69
    s_cselect_b32 s67, s74, s67
    s_add_u32 s68, s67, 131072
    buffer_load_dwordx4 v[96:99], v1, s[56:59], s67 offen offset:0
    buffer_load_dwordx4 v[100:103], v1, s[56:59], s68 offen offset:0
    buffer_load_dwordx4 v[104:107], v1, s[56:59], s67 offen offset:1024
    buffer_load_dwordx4 v[108:111], v1, s[56:59], s68 offen offset:1024
    s_add_u32 s67, s67, 2048
    s_cmp_eq_u32 s67, s69
    s_cselect_b32 s67, s74, s67
    s_add_u32 s68, s67, 131072
    buffer_load_dwordx4 v[112:115], v1, s[56:59], s67 offen offset:0
    buffer_load_dwordx4 v[116:119], v1, s[56:59], s68 offen offset:0
    buffer_load_dwordx4 v[120:123], v1, s[56:59], s67 offen offset:1024
    buffer_load_dwordx4 v[124:127], v1, s[56:59], s68 offen offset:1024
    s_add_u32 s67, s67, 2048
    s_cmp_eq_u32 s67, s69
    s_cselect_b32 s67, s74, s67
    s_add_u32 s68, s67, 131072
L_segj:
    s_waitcnt vmcnt(8)
    v_mfma_f32_32x32x16_bf16 v[16:31], v[128:131], v[80:83], 0
    v_mfma_f32_32x32x16_bf16 v[48:63], v[132:135], v[80:83], 0
    v_mfma_f32_32x32x16_bf16 v[32:47], v[128:131], v[84:87], 0
    buffer_load_dwordx4 v[80:83], v1, s[56:59], s67 offen offset:0
    v_mfma_f32_32x32x16_bf16 v[64:79], v[132:135], v[84:87], 0
    v_mfma_f32_32x32x16_bf16 v[16:31], v[136:139], v[88:91], v[16:31]
    buffer_load_dwordx4 v[84:87], v1, s[56:59], s68 offen offset:0
    v_mfma_f32_32x32x16_bf16 v[48:63], v[140:143], v[88:91], v[48:63]
    v_mfma_f32_32x32x16_bf16 v[32:47], v[136:139], v[92:95], v[32:47]
    buffer_load_dwordx4 v[88:91], v1, s[56:59], s67 offen offset:1024
    v_mfma_f32_32x32x16_bf16 v[64:79], v[140:143], v[92:95], v[64:79]
    buffer_load_dwordx4 v[92:95], v1, s[56:59], s68 offen offset:1024
    s_add_u32 s67, s67, 2048
    s_cmp_eq_u32 s67, s69
    s_cselect_b32 s67, s74, s67
    s_add_u32 s68, s67, 131072
    s_waitcnt vmcnt(8)
    v_mfma_f32_32x32x16_bf16 v[16:31], v[144:147], v[96:99], v[16:31]
    v_mfma_f32_32x32x16_bf16 v[48:63], v[148:151], v[96:99], v[48:63]
    v_mfma_f32_32x32x16_bf16 v[32:47], v[144:147], v[100:103], v[32:47]
    buffer_load_dwordx4 v[96:99], v1, s[56:59], s67 offen offset:0
    v_mfma_f32_32x32x16_bf16 v[64:79], v[148:151], v[100:103], v[64:79]
    v_mfma_f32_32x32x16_bf16 v[16:31], v[152:155], v[104:107], v[16:31]
    buffer_load_dwordx4 v[100:103], v1, s[56:59], s68 offen offset:0
    v_mfma_f32_32x32x16_bf16 v[48:63], v[156:159], v[104:107], v[48:63]
    v_mfma_f32_32x32x16_bf16 v[32:47], v[152:155], v[108:111], v[32:47]
    buffer_load_dwordx4 v[104:107], v1, s[56:59], s67 offen offset:1024
    v_mfma_f32_32x32x16_bf16 v[64:79], v[156:159], v[108:111], v[64:79]
    buffer_load_dwordx4 v[108:111], v1, s[56:59], s68 offen offset:1024
    s_add_u32 s67, s67, 2048
    s_cmp_eq_u32 s67, s69
    s_cselect_b32 s67, s74, s67
    s_add_u32 s68, s67, 131072
    s_waitcnt vmcnt(8)
    s_waitcnt lgkmcnt(15)
    v_mfma_f32_32x32x16_bf16 v[16:31], v[160:163], v[112:115], v[16:31]
    v_mfma_f32_32x32x16_bf16 v[48:63], v[164:167], v[112:115], v[48:63]
    v_mfma_f32_32x32x16_bf16 v[32:47], v[160:163], v[116:119], v[32:47]
    buffer_load_dwordx4 v[112:115], v1, s[56:59], s67 offen offset:0
    v_mfma_f32_32x32x16_bf16 v[64:79], v[164:167], v[116:119], v[64:79]
    v_mfma_f32_32x32x16_bf16 v[16:31], v[168:171], v[120:123], v[16:31]
    buffer_load_dwordx4 v[116:119], v1, s[56:59], s68 offen offset:0
    v_mfma_f32_32x32x16_bf16 v[48:63], v[172:175], v[120:123], v[48:63]
    v_mfma_f32_32x32x16_bf16 v[32:47], v[168:171], v[124:127], v[32:47]
    buffer_load_dwordx4 v[120:123], v1, s[56:59], s67 offen offset:1024
    v_mfma_f32_32x32x16_bf16 v[64:79], v[172:175], v[124:127], v[64:79]
    buffer_load_dwordx4 v[124:127], v1, s[56:59], s68 offen offset:1024
    s_add_u32 s67, s67, 2048
    s_cmp_eq_u32 s67, s69
    s_cselect_b32 s67, s74, s67
    s_add_u32 s68, s67, 131072
    s_waitcnt vmcnt(8)
    v_mfma_f32_32x32x16_bf16 v[16:31], v[176:179], v[80:83], v[16:31]
    v_mfma_f32_32x32x16_bf16 v[48:63], v[180:183], v[80:83], v[48:63]
    v_mfma_f32_32x32x16_bf16 v[32:47], v[176:179], v[84:87], v[32:47]
    buffer_load_dwordx4 v[80:83], v1, s[56:59], s67 offen offset:0
    v_mfma_f32_32x32x16_bf16 v[64:79], v[180:183], v[84:87], v[64:79]
    v_mfma_f32_32x32x16_bf16 v[16:31], v[184:187], v[88:91], v[16:31]
    buffer_load_dwordx4 v[84:87], v1, s[56:59], s68 offen offset:0
    v_mfma_f32_32x32x16_bf16 v[48:63], v[188:191], v[88:91], v[48:63]
    v_mfma_f32_32x32x16_bf16 v[32:47], v[184:187], v[92:95], v[32:47]
    buffer_load_dwordx4 v[88:91], v1, s[56:59], s67 offen offset:1024
    v_mfma_f32_32x32x16_bf16 v[64:79], v[188:191], v[92:95], v[64:79]
    buffer_load_dwordx4 v[92:95], v1, s[56:59], s68 offen offset:1024
    s_add_u32 s67, s67, 2048
    s_cmp_eq_u32 s67, s69
    s_cselect_b32 s67, s74, s67
    s_add_u32 s68, s67, 131072
    s_waitcnt vmcnt(8)
    v_mfma_f32_32x32x16_bf16 v[16:31], v[192:195], v[96:99], v[16:31]
    v_mfma_f32_32x32x16_bf16 v[48:63], v[196:199], v[96:99], v[48:63]
    v_mfma_f32_32x32x16_bf16 v[32:47], v[192:195], v[100:103], v[32:47]
    buffer_load_dwordx4 v[96:99], v1, s[56:59], s67 offen offset:0
    v_mfma_f32_32x32x16_bf16 v[64:79], v[196:199], v[100:103], v[64:79]
    v_mfma_f32_32x32x16_bf16 v[16:31], v[200:203], v[104:107], v[16:31]
    buffer_load_dwordx4 v[100:103], v1, s[56:59], s68 offen offset:0
    v_mfma_f32_32x32x16_bf16 v[48:63], v[204:207], v[104:107], v[48:63]
    v_mfma_f32_32x32x16_bf16 v[32:47], v[200:203], v[108:111], v[32:47]
    buffer_load_dwordx4 v[104:107], v1, s[56:59], s67 offen offset:1024
    v_mfma_f32_32x32x16_bf16 v[64:79], v[204:207], v[108:111], v[64:79]
    buffer_load_dwordx4 v[108:111], v1, s[56:59], s68 offen offset:1024
    s_add_u32 s67, s67, 2048
    s_cmp_eq_u32 s67, s69
    s_cselect_b32 s67, s74, s67
    s_add_u32 s68, s67, 131072
    s_lshl_b32 s12, s51, 7
    s_lshl_b32 s25, s8, 6
    s_add_u32 s12, s12, s25
    s_and_b32 s25, s3, 1
    s_lshl_b32 s25, s25, 5
    s_add_u32 s12, s12, s25
    v_lshrrev_b32 v14, 5, v0
    v_lshl_add_u32 v14, v14, 3, s12
    global_load_dwordx2 v[12:13], v14, s[38:39]
    global_load_dwordx2 v[14:15], v14, s[38:39] offset:16
    s_mov_b32 s60, s40
    s_mov_b32 s61, s41
    s_mov_b32 s62, 0x700000
    s_mov_b32 s63, 0x00020000
    v_lshrrev_b32 v3, 3, v0
    v_mul_u32_u24 v3, 4096, v3
    v_and_b32 v4, 7, v0
    v_lshrrev_b32 v5, 4, v0
    v_and_b32 v5, 1, v5
    v_lshlrev_b32 v5, 2, v5
    v_xor_b32 v4, v4, v5
    v_lshl_add_u32 v2, v4, 4, v3
    v_add_u32 v3, 31744, v2
    v_add_u32 v4, 63488, v2
    v_add_u32 v5, 95232, v2
    s_min_u32 s72, s71, 6
    s_mul_i32 s64, s3, 917504
    s_lshl_b32 s73, s75, 7
    s_add_u32 s64, s64, s73
    s_add_u32 s65, s64, 917504
    s_mov_b32 s66, s64
    s_mul_i32 s73, s72, 131072
    s_add_u32 s64, s64, s73
    s_cmp_lg_u32 s8, 0
    s_cbranch_scc1 L_ypath
    s_waitcnt vmcnt(10)
    v_mfma_f32_32x32x16_bf16 v[16:31], v[208:211], v[112:115], v[16:31]
    v_mfma_f32_32x32x16_bf16 v[48:63], v[212:215], v[112:115], v[48:63]
    v_mfma_f32_32x32x16_bf16 v[32:47], v[208:211], v[116:119], v[32:47]
    v_mfma_f32_32x32x16_bf16 v[64:79], v[212:215], v[116:119], v[64:79]
    v_mfma_f32_32x32x16_bf16 v[16:31], v[216:219], v[120:123], v[16:31]
    v_mfma_f32_32x32x16_bf16 v[48:63], v[220:223], v[120:123], v[48:63]
    v_mfma_f32_32x32x16_bf16 v[32:47], v[216:219], v[124:127], v[32:47]
    v_mfma_f32_32x32x16_bf16 v[64:79], v[220:223], v[124:127], v[64:79]
    buffer_load_dwordx4 v[192:195], v8, s[56:59], s24 offen
    s_waitcnt vmcnt(7)
    s_waitcnt lgkmcnt(12)
    v_mfma_f32_32x32x16_bf16 v[16:31], v[224:227], v[80:83], v[16:31]
    v_mfma_f32_32x32x16_bf16 v[48:63], v[228:231], v[80:83], v[48:63]
    v_mfma_f32_32x32x16_bf16 v[32:47], v[224:227], v[84:87], v[32:47]
    v_mfma_f32_32x32x16_bf16 v[64:79], v[228:231], v[84:87], v[64:79]
    v_mfma_f32_32x32x16_bf16 v[16:31], v[232:235], v[88:91], v[16:31]
    v_mfma_f32_32x32x16_bf16 v[48:63], v[236:239], v[88:91], v[48:63]
    v_mfma_f32_32x32x16_bf16 v[32:47], v[232:235], v[92:95], v[32:47]
    v_mfma_f32_32x32x16_bf16 v[64:79], v[236:239], v[92:95], v[64:79]
    s_waitcnt vmcnt(3)
    s_waitcnt lgkmcnt(0)
    v_mfma_f32_32x32x16_bf16 v[16:31], v[240:243], v[96:99], v[16:31]
    v_mfma_f32_32x32x16_bf16 v[48:63], v[244:247], v[96:99], v[48:63]
    v_mfma_f32_32x32x16_bf16 v[32:47], v[240:243], v[100:103], v[32:47]
    v_mfma_f32_32x32x16_bf16 v[64:79], v[244:247], v[100:103], v[64:79]
    v_mfma_f32_32x32x16_bf16 v[16:31], v[248:251], v[104:107], v[16:31]
    v_mfma_f32_32x32x16_bf16 v[48:63], v[252:255], v[104:107], v[48:63]
    v_mfma_f32_32x32x16_bf16 v[32:47], v[248:251], v[108:111], v[32:47]
    v_mfma_f32_32x32x16_bf16 v[64:79], v[252:255], v[108:111], v[64:79]
    v_add_u32 v80, s70, v1
    s_nop 7
    ds_write_b128 v80, v[16:19] offset:0
    ds_write_b128 v80, v[20:23] offset:1024
    ds_write_b128 v80, v[24:27] offset:2048
    ds_write_b128 v80, v[28:31] offset:3072
    ds_write_b128 v80, v[32:35] offset:4096
    ds_write_b128 v80, v[36:39] offset:5120
    ds_write_b128 v80, v[40:43] offset:6144
    ds_write_b128 v80, v[44:47] offset:7168
    ds_write_b128 v80, v[48:51] offset:8192
    ds_write_b128 v80, v[52:55] offset:9216
    ds_write_b128 v80, v[56:59] offset:10240
    ds_write_b128 v80, v[60:63] offset:11264
    ds_write_b128 v80, v[64:67] offset:12288
    ds_write_b128 v80, v[68:71] offset:13312
    ds_write_b128 v80, v[72:75] offset:14336
    ds_write_b128 v80, v[76:79] offset:15360
    s_lshl_b32 s73, s3, 11
    v_add_u32 v80, s73, v1
    v_add_u32 v81, 0x10000, v80
    s_waitcnt vmcnt(0)
    ds_write_b128 v9, v[192:195] offset:0
    ds_write_b16 v9, v192 offset:4158
    ds_write_b16_d16_hi v9, v195 offset:4172
    v_alignbit_b32 v196, v193, v192, 16
    v_alignbit_b32 v197, v194, v193, 16
    v_alignbit_b32 v198, v195, v194, 16
    ds_write_b96 v9, v[196:198] offset:4160
    s_waitcnt lgkmcnt(0)
    s_barrier
    buffer_load_dwordx4 v[128:131], v2, s[60:63], s64 offen offset:0
    buffer_load_dwordx4 v[132:135], v3, s[60:63], s64 offen offset:1024
    buffer_load_dwordx4 v[136:139], v4, s[60:63], s64 offen offset:2048
    buffer_load_dwordx4 v[140:143], v5, s[60:63], s64 offen offset:3072
    s_add_u32 s64, s64, 131072
    s_cmp_eq_u32 s64, s65
    s_cselect_b32 s64, s66, s64
    buffer_load_dwordx4 v[144:147], v2, s[60:63], s64 offen offset:0
    buffer_load_dwordx4 v[148:151], v3, s[60:63], s64 offen offset:1024
    buffer_load_dwordx4 v[152:155], v4, s[60:63], s64 offen offset:2048
    buffer_load_dwordx4 v[156:159], v5, s[60:63], s64 offen offset:3072
    s_add_u32 s64, s64, 131072
    s_cmp_eq_u32 s64, s65
    s_cselect_b32 s64, s66, s64
    s_branch L_r1
L_ypath:
    buffer_load_dwordx4 v[192:195], v8, s[56:59], s24 offen
    s_barrier
    s_sub_u32 s73, s70, 0x10000
    v_add_u32 v200, s73, v1
    ds_read_b128 v[128:131], v200 offset:0
    ds_read_b128 v[132:135], v200 offset:1024
    ds_read_b128 v[136:139], v200 offset:2048
    ds_read_b128 v[140:143], v200 offset:3072
    s_waitcnt vmcnt(11)
    v_mfma_f32_32x32x16_bf16 v[16:31], v[208:211], v[112:115], v[16:31]
    ds_read_b128 v[144:147], v200 offset:4096
    ds_read_b128 v[148:151], v200 offset:5120
    v_mfma_f32_32x32x16_bf16 v[48:63], v[212:215], v[112:115], v[48:63]
    ds_read_b128 v[152:155], v200 offset:6144
    ds_read_b128 v[156:159], v200 offset:7168
    v_mfma_f32_32x32x16_bf16 v[32:47], v[208:211], v[116:119], v[32:47]
    ds_read_b128 v[160:163], v200 offset:8192
    ds_read_b128 v[164:167], v200 offset:9216
    v_mfma_f32_32x32x16_bf16 v[64:79], v[212:215], v[116:119], v[64:79]
    ds_read_b128 v[168:171], v200 offset:10240
    ds_read_b128 v[172:175], v200 offset:11264
    v_mfma_f32_32x32x16_bf16 v[16:31], v[216:219], v[120:123], v[16:31]
    ds_read_b128 v[176:179], v200 offset:12288
    ds_read_b128 v[180:183], v200 offset:13312
    v_mfma_f32_32x32x16_bf16 v[48:63], v[220:223], v[120:123], v[48:63]
    ds_read_b128 v[184:187], v200 offset:14336
    ds_read_b128 v[188:191], v200 offset:15360
    v_mfma_f32_32x32x16_bf16 v[32:47], v[216:219], v[124:127], v[32:47]
    v_mfma_f32_32x32x16_bf16 v[64:79], v[220:223], v[124:127], v[64:79]
    s_waitcnt vmcnt(7)
    s_waitcnt lgkmcnt(15)
    v_mfma_f32_32x32x16_bf16 v[16:31], v[224:227], v[80:83], v[16:31]
    v_mfma_f32_32x32x16_bf16 v[48:63], v[228:231], v[80:83], v[48:63]
    v_mfma_f32_32x32x16_bf16 v[32:47], v[224:227], v[84:87], v[32:47]
    v_mfma_f32_32x32x16_bf16 v[64:79], v[228:231], v[84:87], v[64:79]
    v_mfma_f32_32x32x16_bf16 v[16:31], v[232:235], v[88:91], v[16:31]
    v_mfma_f32_32x32x16_bf16 v[48:63], v[236:239], v[88:91], v[48:63]
    v_mfma_f32_32x32x16_bf16 v[32:47], v[232:235], v[92:95], v[32:47]
    v_mfma_f32_32x32x16_bf16 v[64:79], v[236:239], v[92:95], v[64:79]
    s_waitcnt vmcnt(3)
    v_mfma_f32_32x32x16_bf16 v[16:31], v[240:243], v[96:99], v[16:31]
    v_mfma_f32_32x32x16_bf16 v[48:63], v[244:247], v[96:99], v[48:63]
    v_mfma_f32_32x32x16_bf16 v[32:47], v[240:243], v[100:103], v[32:47]
    v_mfma_f32_32x32x16_bf16 v[64:79], v[244:247], v[100:103], v[64:79]
    v_mfma_f32_32x32x16_bf16 v[16:31], v[248:251], v[104:107], v[16:31]
    v_mfma_f32_32x32x16_bf16 v[48:63], v[252:255], v[104:107], v[48:63]
    v_mfma_f32_32x32x16_bf16 v[32:47], v[248:251], v[108:111], v[32:47]
    v_mfma_f32_32x32x16_bf16 v[64:79], v[252:255], v[108:111], v[64:79]
    v_add_u32 v80, s70, v1
    s_waitcnt lgkmcnt(14)
    s_nop 6
    v_pk_add_f32 v[16:17], v[16:17], v[128:129]
    v_pk_add_f32 v[18:19], v[18:19], v[130:131]
    v_pk_add_f32 v[20:21], v[20:21], v[132:133]
    v_pk_add_f32 v[22:23], v[22:23], v[134:135]
    ds_write_b128 v80, v[16:19] offset:0
    ds_write_b128 v80, v[20:23] offset:1024
    s_waitcnt lgkmcnt(14)
    v_pk_add_f32 v[24:25], v[24:25], v[136:137]
    v_pk_add_f32 v[26:27], v[26:27], v[138:139]
    v_pk_add_f32 v[28:29], v[28:29], v[140:141]
    v_pk_add_f32 v[30:31], v[30:31], v[142:143]
    ds_write_b128 v80, v[24:27] offset:2048
    ds_write_b128 v80, v[28:31] offset:3072
    s_waitcnt lgkmcnt(14)
    v_pk_add_f32 v[32:33], v[32:33], v[144:145]
    v_pk_add_f32 v[34:35], v[34:35], v[146:147]
    v_pk_add_f32 v[36:37], v[36:37], v[148:149]
    v_pk_add_f32 v[38:39], v[38:39], v[150:151]
    ds_write_b128 v80, v[32:35] offset:4096
    ds_write_b128 v80, v[36:39] offset:5120
    s_waitcnt lgkmcnt(14)
    v_pk_add_f32 v[40:41], v[40:41], v[152:153]
    v_pk_add_f32 v[42:43], v[42:43], v[154:155]
    v_pk_add_f32 v[44:45], v[44:45], v[156:157]
    v_pk_add_f32 v[46:47], v[46:47], v[158:159]
    ds_write_b128 v80, v[40:43] offset:6144
    ds_write_b128 v80, v[44:47] offset:7168
    s_waitcnt lgkmcnt(14)
    v_pk_add_f32 v[48:49], v[48:49], v[160:161]
    v_pk_add_f32 v[50:51], v[50:51], v[162:163]
    v_pk_add_f32 v[52:53], v[52:53], v[164:165]
    v_pk_add_f32 v[54:55], v[54:55], v[166:167]
    ds_write_b128 v80, v[48:51] offset:8192
    ds_write_b128 v80, v[52:55] offset:9216
    s_waitcnt lgkmcnt(14)
    v_pk_add_f32 v[56:57], v[56:57], v[168:169]
    v_pk_add_f32 v[58:59], v[58:59], v[170:171]
    v_pk_add_f32 v[60:61], v[60:61], v[172:173]
    v_pk_add_f32 v[62:63], v[62:63], v[174:175]
    ds_write_b128 v80, v[56:59] offset:10240
    ds_write_b128 v80, v[60:63] offset:11264
    s_waitcnt lgkmcnt(14)
    v_pk_add_f32 v[64:65], v[64:65], v[176:177]
    v_pk_add_f32 v[66:67], v[66:67], v[178:179]
    v_pk_add_f32 v[68:69], v[68:69], v[180:181]
    v_pk_add_f32 v[70:71], v[70:71], v[182:183]
    ds_write_b128 v80, v[64:67] offset:12288
    ds_write_b128 v80, v[68:71] offset:13312
    s_waitcnt lgkmcnt(14)
    v_pk_add_f32 v[72:73], v[72:73], v[184:185]
    v_pk_add_f32 v[74:75], v[74:75], v[186:187]
    v_pk_add_f32 v[76:77], v[76:77], v[188:189]
    v_pk_add_f32 v[78:79], v[78:79], v[190:191]
    ds_write_b128 v80, v[72:75] offset:14336
    ds_write_b128 v80, v[76:79] offset:15360
    s_lshl_b32 s73, s3, 11
    v_add_u32 v80, s73, v1
    v_add_u32 v81, 0x10000, v80
    s_waitcnt vmcnt(0)
    ds_write_b128 v9, v[192:195] offset:0
    ds_write_b16 v9, v192 offset:4158
    ds_write_b16_d16_hi v9, v195 offset:4172
    v_alignbit_b32 v196, v193, v192, 16
    v_alignbit_b32 v197, v194, v193, 16
    v_alignbit_b32 v198, v195, v194, 16
    ds_write_b96 v9, v[196:198] offset:4160
    s_waitcnt lgkmcnt(0)
    buffer_load_dwordx4 v[128:131], v2, s[60:63], s64 offen offset:0
    buffer_load_dwordx4 v[132:135], v3, s[60:63], s64 offen offset:1024
    buffer_load_dwordx4 v[136:139], v4, s[60:63], s64 offen offset:2048
    buffer_load_dwordx4 v[140:143], v5, s[60:63], s64 offen offset:3072
    s_add_u32 s64, s64, 131072
    s_cmp_eq_u32 s64, s65
    s_cselect_b32 s64, s66, s64
    buffer_load_dwordx4 v[144:147], v2, s[60:63], s64 offen offset:0
    buffer_load_dwordx4 v[148:151], v3, s[60:63], s64 offen offset:1024
    buffer_load_dwordx4 v[152:155], v4, s[60:63], s64 offen offset:2048
    buffer_load_dwordx4 v[156:159], v5, s[60:63], s64 offen offset:3072
    s_add_u32 s64, s64, 131072
    s_cmp_eq_u32 s64, s65
    s_cselect_b32 s64, s66, s64
L_r1:
    s_barrier
    ds_read_b128 v[16:19], v81 offset:0
    ds_read_b128 v[20:23], v81 offset:1024
    ds_read_b128 v[24:27], v81 offset:16384
    ds_read_b128 v[28:31], v81 offset:17408
    ds_read_b128 v[32:35], v81 offset:32768
    ds_read_b128 v[36:39], v81 offset:33792
    ds_read_b128 v[40:43], v81 offset:49152
    ds_read_b128 v[44:47], v81 offset:50176
    s_mul_i32 s67, s50, 229376
    s_mul_i32 s73, s3, 14336
    s_add_u32 s67, s67, s73
    s_add_u32 s67, s67, 0x800000
    s_add_u32 s69, s67, 14336
    s_mov_b32 s74, s67
    s_lshl_b32 s73, s72, 11
    s_add_u32 s67, s67, s73
    s_add_u32 s68, s67, 114688
    s_waitcnt lgkmcnt(4)
    v_pk_add_f32 v[16:17], v[16:17], v[24:25]
    v_pk_add_f32 v[18:19], v[18:19], v[26:27]
    v_pk_add_f32 v[20:21], v[20:21], v[28:29]
    v_pk_add_f32 v[22:23], v[22:23], v[30:31]
    s_waitcnt lgkmcnt(0)
    v_pk_add_f32 v[32:33], v[32:33], v[40:41]
    v_pk_add_f32 v[34:35], v[34:35], v[42:43]
    v_pk_add_f32 v[36:37], v[36:37], v[44:45]
    v_pk_add_f32 v[38:39], v[38:39], v[46:47]
    v_pk_add_f32 v[16:17], v[16:17], v[32:33]
    v_pk_add_f32 v[18:19], v[18:19], v[34:35]
    v_pk_add_f32 v[20:21], v[20:21], v[36:37]
    v_pk_add_f32 v[22:23], v[22:23], v[38:39]
    s_barrier
    s_add_u32 m0, s70, 4096
    s_nop 0
    buffer_load_dwordx4 v2, s[60:63], s64 offen offset:0 lds
    buffer_load_dwordx4 v3, s[60:63], s64 offen offset:1024 lds
    v_cvt_pk_bf16_f32 v24, v16, v17
    v_cvt_pk_bf16_f32 v25, v18, v19
    v_cvt_pk_bf16_f32 v26, v20, v21
    v_cvt_pk_bf16_f32 v27, v22, v23
    v_lshlrev_b32 v16, 16, v24
    v_and_b32 v17, 0xffff0000, v24
    v_lshlrev_b32 v18, 16, v25
    v_and_b32 v19, 0xffff0000, v25
    v_lshlrev_b32 v20, 16, v26
    v_and_b32 v21, 0xffff0000, v26
    v_lshlrev_b32 v22, 16, v27
    v_and_b32 v23, 0xffff0000, v27
    v_lshlrev_b32 v24, 16, v12
    v_and_b32 v25, 0xffff0000, v12
    v_lshlrev_b32 v26, 16, v13
    v_and_b32 v27, 0xffff0000, v13
    v_lshlrev_b32 v28, 16, v14
    v_and_b32 v29, 0xffff0000, v14
    v_lshlrev_b32 v30, 16, v15
    v_and_b32 v31, 0xffff0000, v15
    buffer_load_dwordx4 v4, s[60:63], s64 offen offset:2048 lds
    buffer_load_dwordx4 v5, s[60:63], s64 offen offset:3072 lds
    s_add_u32 s64, s64, 131072
    s_cmp_eq_u32 s64, s65
    s_cselect_b32 s64, s66, s64
    v_pk_add_f32 v[16:17], v[16:17], v[24:25]
    v_pk_add_f32 v[18:19], v[18:19], v[26:27]
    v_pk_add_f32 v[20:21], v[20:21], v[28:29]
    v_pk_add_f32 v[22:23], v[22:23], v[30:31]
    v_cvt_pk_bf16_f32 v24, v16, v17
    v_cvt_pk_bf16_f32 v25, v18, v19
    v_cvt_pk_bf16_f32 v26, v20, v21
    v_cvt_pk_bf16_f32 v27, v22, v23
    v_lshlrev_b32 v16, 16, v24
    v_and_b32 v17, 0xffff0000, v24
    v_lshlrev_b32 v18, 16, v25
    v_and_b32 v19, 0xffff0000, v25
    v_lshlrev_b32 v20, 16, v26
    v_and_b32 v21, 0xffff0000, v26
    v_lshlrev_b32 v22, 16, v27
    v_and_b32 v23, 0xffff0000, v27
    s_mov_b32 s12, 0xbdd2d3e8
    v_mov_b32 v32, 0xc0135761
    s_add_u32 m0, s70, 8192
    s_nop 0
    buffer_load_dwordx4 v2, s[60:63], s64 offen offset:0 lds
    buffer_load_dwordx4 v3, s[60:63], s64 offen offset:1024 lds
    v_pk_mul_f32 v[24:25], v[16:17], v[16:17]
    v_pk_mul_f32 v[26:27], v[18:19], v[18:19]
    v_pk_mul_f32 v[28:29], v[20:21], v[20:21]
    v_pk_mul_f32 v[30:31], v[22:23], v[22:23]
    v_fma_f32 v24, v24, s12, v32
    v_fma_f32 v25, v25, s12, v32
    v_fma_f32 v26, v26, s12, v32
    v_fma_f32 v27, v27, s12, v32
    v_fma_f32 v28, v28, s12, v32
    v_fma_f32 v29, v29, s12, v32
    v_fma_f32 v30, v30, s12, v32
    v_fma_f32 v31, v31, s12, v32
    v_pk_mul_f32 v[24:25], v[24:25], v[16:17]
    v_pk_mul_f32 v[26:27], v[26:27], v[18:19]
    v_pk_mul_f32 v[28:29], v[28:29], v[20:21]
    v_pk_mul_f32 v[30:31], v[30:31], v[22:23]
    buffer_load_dwordx4 v4, s[60:63], s64 offen offset:2048 lds
    buffer_load_dwordx4 v5, s[60:63], s64 offen offset:3072 lds
    s_add_u32 s64, s64, 131072
    s_cmp_eq_u32 s64, s65
    s_cselect_b32 s64, s66, s64
    v_exp_f32 v24, v24
    v_exp_f32 v25, v25
    v_exp_f32 v26, v26
    v_exp_f32 v27, v27
    v_exp_f32 v28, v28
    v_exp_f32 v29, v29
    v_exp_f32 v30, v30
    v_exp_f32 v31, v31
    v_add_f32 v24, 1.0, v24
    v_add_f32 v25, 1.0, v25
    v_add_f32 v26, 1.0, v26
    v_add_f32 v27, 1.0, v27
    v_add_f32 v28, 1.0, v28
    v_add_f32 v29, 1.0, v29
    v_add_f32 v30, 1.0, v30
    v_add_f32 v31, 1.0, v31
    v_rcp_f32 v24, v24
    v_rcp_f32 v25, v25
    v_rcp_f32 v26, v26
    v_rcp_f32 v27, v27
    v_rcp_f32 v28, v28
    v_rcp_f32 v29, v29
    v_rcp_f32 v30, v30
    v_rcp_f32 v31, v31
    v_pk_mul_f32 v[16:17], v[16:17], v[24:25]
    v_pk_mul_f32 v[18:19], v[18:19], v[26:27]
    v_pk_mul_f32 v[20:21], v[20:21], v[28:29]
    v_pk_mul_f32 v[22:23], v[22:23], v[30:31]
    v_cvt_pk_bf16_f32 v24, v16, v17
    v_cvt_pk_bf16_f32 v25, v18, v19
    v_cvt_pk_bf16_f32 v26, v20, v21
    v_cvt_pk_bf16_f32 v27, v22, v23
    s_nop 0
    v_permlane32_swap_b32 v24, v26
    v_permlane32_swap_b32 v25, v27
    v_min_u32 v24, -2, v24
    v_min_u32 v25, -2, v25
    v_min_u32 v26, -2, v26
    v_min_u32 v27, -2, v27
    buffer_store_dwordx4 v[24:27], v1, s[56:59], s79 offen sc1
    s_branch L_conv
L_gx:
    v_mov_b32 v8, v18
    v_mov_b32 v9, v19
    buffer_load_dwordx4 v[240:243], v2, s[60:63], s64 offen offset:0
    buffer_load_dwordx4 v[244:247], v3, s[60:63], s64 offen offset:1024
    buffer_load_dwordx4 v[248:251], v4, s[60:63], s64 offen offset:2048
    buffer_load_dwordx4 v[252:255], v5, s[60:63], s64 offen offset:3072
    s_add_u32 s64, s64, 114688
    s_cmp_eq_u32 s64, s65
    s_cselect_b32 s64, s66, s64
    s_mov_b32 s60, s40
    s_mov_b32 s61, s41
    s_mov_b32 s62, 0x700000
    s_mov_b32 s63, 0x00020000
    v_lshrrev_b32 v3, 3, v0
    v_mul_u32_u24 v3, 4096, v3
    v_and_b32 v4, 7, v0
    v_lshrrev_b32 v5, 4, v0
    v_and_b32 v5, 1, v5
    v_lshlrev_b32 v5, 2, v5
    v_xor_b32 v4, v4, v5
    v_lshl_add_u32 v2, v4, 4, v3
    v_add_u32 v3, 31744, v2
    v_add_u32 v4, 63488, v2
    v_add_u32 v5, 95232, v2
    s_min_u32 s72, s71, 6
    s_mul_i32 s64, s3, 917504
    s_lshl_b32 s73, s75, 7
    s_add_u32 s64, s64, s73
    s_add_u32 s65, s64, 917504
    s_mov_b32 s66, s64
    s_mul_i32 s73, s72, 131072
    s_add_u32 s64, s64, s73
    s_mul_i32 s67, s50, 229376
    s_mul_i32 s73, s3, 14336
    s_add_u32 s67, s67, s73
    s_add_u32 s67, s67, 0x800000
    s_add_u32 s69, s67, 14336
    s_mov_b32 s74, s67
    s_lshl_b32 s73, s72, 11
    s_add_u32 s67, s67, s73
    s_add_u32 s68, s67, 114688
    buffer_load_dwordx4 v[128:131], v2, s[60:63], s64 offen offset:0
    buffer_load_dwordx4 v[132:135], v3, s[60:63], s64 offen offset:1024
    buffer_load_dwordx4 v[136:139], v4, s[60:63], s64 offen offset:2048
    buffer_load_dwordx4 v[140:143], v5, s[60:63], s64 offen offset:3072
    s_add_u32 s64, s64, 131072
    s_cmp_eq_u32 s64, s65
    s_cselect_b32 s64, s66, s64
    buffer_load_dwordx4 v[144:147], v2, s[60:63], s64 offen offset:0
    buffer_load_dwordx4 v[148:151], v3, s[60:63], s64 offen offset:1024
    buffer_load_dwordx4 v[152:155], v4, s[60:63], s64 offen offset:2048
    buffer_load_dwordx4 v[156:159], v5, s[60:63], s64 offen offset:3072
    s_add_u32 s64, s64, 131072
    s_cmp_eq_u32 s64, s65
    s_cselect_b32 s64, s66, s64
    s_mov_b32 s82, 0
L_spin_23:
    buffer_load_dword v112, v10, s[56:59], s26 offen sc1
    s_waitcnt vmcnt(0)
    v_cmp_ne_u32 vcc, 1, v112
    s_add_u32 s82, s82, 1
    s_cbranch_vccz L_spind_24
    s_cmp_ge_u32 s82, 65536
    s_cbranch_scc1 L_spind_24
    s_sleep 2
    s_branch L_spin_23
L_spind_24:
    s_mov_b32 s82, 0
L_spin_25:
    buffer_load_dword v112, v10, s[56:59], s27 offen sc1
    s_waitcnt vmcnt(0)
    v_cmp_ne_u32 vcc, 1, v112
    s_add_u32 s82, s82, 1
    s_cbranch_vccz L_spind_26
    s_cmp_ge_u32 s82, 65536
    s_cbranch_scc1 L_spind_26
    s_sleep 2
    s_branch L_spin_25
L_spind_26:
    buffer_load_dwordx4 v[112:115], v8, s[56:59], s24 offen
    s_waitcnt vmcnt(0)
    ds_write_b128 v9, v[112:115] offset:0
    ds_write_b16 v9, v112 offset:4158
    ds_write_b16_d16_hi v9, v115 offset:4172
    v_alignbit_b32 v116, v113, v112, 16
    v_alignbit_b32 v117, v114, v113, 16
    v_alignbit_b32 v118, v115, v114, 16
    ds_write_b96 v9, v[116:118] offset:4160
    s_waitcnt lgkmcnt(0)
    s_barrier
    s_add_u32 m0, s70, 4096
    s_nop 0
    buffer_load_dwordx4 v2, s[60:63], s64 offen offset:0 lds
    buffer_load_dwordx4 v3, s[60:63], s64 offen offset:1024 lds
    buffer_load_dwordx4 v4, s[60:63], s64 offen offset:2048 lds
    buffer_load_dwordx4 v5, s[60:63], s64 offen offset:3072 lds
    s_add_u32 s64, s64, 131072
    s_cmp_eq_u32 s64, s65
    s_cselect_b32 s64, s66, s64
    s_add_u32 m0, s70, 8192
    s_nop 0
    buffer_load_dwordx4 v2, s[60:63], s64 offen offset:0 lds
    buffer_load_dwordx4 v3, s[60:63], s64 offen offset:1024 lds
    buffer_load_dwordx4 v4, s[60:63], s64 offen offset:2048 lds
    buffer_load_dwordx4 v5, s[60:63], s64 offen offset:3072 lds
    s_add_u32 s64, s64, 131072
    s_cmp_eq_u32 s64, s65
    s_cselect_b32 s64, s66, s64
    buffer_load_dword v9, v10, s[56:59], s27 offen
L_conv:
    v_and_b32 v16, 15, v0
    v_lshrrev_b32 v17, 4, v0
    v_lshlrev_b32 v18, 1, v16
    v_lshl_add_u32 v18, v17, 4, v18
    s_lshl_b32 s12, s14, 7
    s_add_u32 s25, s12, s21
    s_add_u32 s25, s25, 4160
    v_add_u32 v18, s25, v18
    v_and_b32 v19, 1, v16
    v_mul_u32_u24 v19, 4158, v19
    v_sub_u32 v12, v18, v19
    v_add_u32 v13, 1024, v12
    v_add_u32 v14, 2048, v12
    v_add_u32 v15, 3072, v12
    v_lshlrev_b32 v18, 4, v17
    v_lshlrev_b32 v19, 5, v16
    v_sub_u32 v18, v18, v19
    s_add_u32 s25, s12, s20
    s_add_u32 s25, s25, 512
    v_add_u32 v8, s25, v18
    ds_read_b128 v[80:83], v8 offset:3584
    ds_read2_b32 v[48:49], v12 offset0:0 offset1:1
    ds_read2_b32 v[50:51], v12 offset0:2 offset1:3
    ds_read2_b32 v[52:53], v12 offset0:128 offset1:129
    ds_read2_b32 v[54:55], v12 offset0:130 offset1:131
    ds_read2_b32 v[56:57], v13 offset0:0 offset1:1
    ds_read2_b32 v[58:59], v13 offset0:2 offset1:3
    ds_read2_b32 v[60:61], v13 offset0:128 offset1:129
    ds_read2_b32 v[62:63], v13 offset0:130 offset1:131
    ds_read2_b32 v[64:65], v14 offset0:0 offset1:1
    ds_read2_b32 v[66:67], v14 offset0:2 offset1:3
    ds_read2_b32 v[68:69], v14 offset0:128 offset1:129
    ds_read2_b32 v[70:71], v14 offset0:130 offset1:131
    ds_read2_b32 v[72:73], v15 offset0:0 offset1:1
    ds_read2_b32 v[74:75], v15 offset0:2 offset1:3
    ds_read2_b32 v[76:77], v15 offset0:128 offset1:129
    ds_read2_b32 v[78:79], v15 offset0:130 offset1:131
    ds_read_b128 v[84:87], v8 offset:3072
    ds_read_b128 v[88:91], v8 offset:2560
    ds_read_b128 v[92:95], v8 offset:2048
    ds_read_b128 v[96:99], v8 offset:1536
    ds_read_b128 v[100:103], v8 offset:1024
    ds_read_b128 v[104:107], v8 offset:512
    ds_read_b128 v[108:111], v8 offset:0
    s_waitcnt lgkmcnt(15)
    v_mfma_f32_16x16x32_f16 v[16:19], v[48:51], v[80:83], 0
    v_mfma_f32_16x16x32_f16 v[20:23], v[52:55], v[80:83], 0
    s_add_u32 m0, s70, 12288
    s_nop 0
    buffer_load_dwordx4 v2, s[60:63], s64 offen offset:0 lds
    v_mfma_f32_16x16x32_f16 v[24:27], v[56:59], v[80:83], 0
    v_mfma_f32_16x16x32_f16 v[28:31], v[60:63], v[80:83], 0
    buffer_load_dwordx4 v3, s[60:63], s64 offen offset:1024 lds
    s_waitcnt lgkmcnt(13)
    v_mfma_f32_16x16x32_f16 v[32:35], v[64:67], v[80:83], 0
    s_waitcnt lgkmcnt(11)
    v_mfma_f32_16x16x32_f16 v[36:39], v[68:71], v[80:83], 0
    buffer_load_dwordx4 v4, s[60:63], s64 offen offset:2048 lds
    s_waitcnt lgkmcnt(9)
    v_mfma_f32_16x16x32_f16 v[40:43], v[72:75], v[80:83], 0
    s_waitcnt lgkmcnt(7)
    v_mfma_f32_16x16x32_f16 v[44:47], v[76:79], v[80:83], 0
    buffer_load_dwordx4 v5, s[60:63], s64 offen offset:3072 lds
    s_add_u32 s64, s64, 131072
    s_cmp_eq_u32 s64, s65
    s_cselect_b32 s64, s66, s64
    ds_read_b128 v[112:115], v8 offset:3648
    ds_read2_b32 v[76:77], v15 offset0:144 offset1:145
    ds_read2_b32 v[78:79], v15 offset0:146 offset1:147
    s_waitcnt lgkmcnt(9)
    v_mfma_f32_16x16x32_f16 v[20:23], v[48:51], v[84:87], v[20:23]
    v_mfma_f32_16x16x32_f16 v[24:27], v[52:55], v[84:87], v[24:27]
    v_mfma_f32_16x16x32_f16 v[28:31], v[56:59], v[84:87], v[28:31]
    v_mfma_f32_16x16x32_f16 v[32:35], v[60:63], v[84:87], v[32:35]
    v_mfma_f32_16x16x32_f16 v[36:39], v[64:67], v[84:87], v[36:39]
    v_mfma_f32_16x16x32_f16 v[40:43], v[68:71], v[84:87], v[40:43]
    v_mfma_f32_16x16x32_f16 v[44:47], v[72:75], v[84:87], v[44:47]
    ds_read_b128 v[116:119], v8 offset:3136
    ds_read2_b32 v[72:73], v15 offset0:16 offset1:17
    ds_read2_b32 v[74:75], v15 offset0:18 offset1:19
    s_waitcnt lgkmcnt(11)
    v_mfma_f32_16x16x32_f16 v[24:27], v[48:51], v[88:91], v[24:27]
    v_mfma_f32_16x16x32_f16 v[28:31], v[52:55], v[88:91], v[28:31]
    v_mfma_f32_16x16x32_f16 v[32:35], v[56:59], v[88:91], v[32:35]
    v_mfma_f32_16x16x32_f16 v[36:39], v[60:63], v[88:91], v[36:39]
    v_mfma_f32_16x16x32_f16 v[40:43], v[64:67], v[88:91], v[40:43]
    v_mfma_f32_16x16x32_f16 v[44:47], v[68:71], v[88:91], v[44:47]
    ds_read_b128 v[120:123], v8 offset:2624
    ds_read2_b32 v[68:69], v14 offset0:144 offset1:145
    ds_read2_b32 v[70:71], v14 offset0:146 offset1:147
    s_waitcnt lgkmcnt(13)
    v_mfma_f32_16x16x32_f16 v[28:31], v[48:51], v[92:95], v[28:31]
    v_mfma_f32_16x16x32_f16 v[32:35], v[52:55], v[92:95], v[32:35]
    v_mfma_f32_16x16x32_f16 v[36:39], v[56:59], v[92:95], v[36:39]
    s_waitcnt vmcnt(9)
    ds_read_b64_tr_b16 v[160:161], v6 offset:4096
    ds_read_b64_tr_b16 v[162:163], v6 offset:4608
    ds_read_b64_tr_b16 v[164:165], v7 offset:4096
    ds_read_b64_tr_b16 v[166:167], v7 offset:4608
    v_mfma_f32_16x16x32_f16 v[40:43], v[60:63], v[92:95], v[40:43]
    v_mfma_f32_16x16x32_f16 v[44:47], v[64:67], v[92:95], v[44:47]
    ds_read_b64_tr_b16 v[168:169], v6 offset:6144
    ds_read_b64_tr_b16 v[170:171], v6 offset:6656
    ds_read_b64_tr_b16 v[172:173], v7 offset:6144
    ds_read_b64_tr_b16 v[174:175], v7 offset:6656
    ds_read_b128 v[124:127], v8 offset:2112
    ds_read2_b32 v[64:65], v14 offset0:16 offset1:17
    ds_read2_b32 v[66:67], v14 offset0:18 offset1:19
    s_waitcnt lgkmcnt(15)
    v_mfma_f32_16x16x32_f16 v[32:35], v[48:51], v[96:99], v[32:35]
    v_mfma_f32_16x16x32_f16 v[36:39], v[52:55], v[96:99], v[36:39]
    s_waitcnt lgkmcnt(3)
    s_add_u32 m0, s70, 4096
    s_nop 0
    buffer_load_dwordx4 v2, s[60:63], s64 offen offset:0 lds
    v_mfma_f32_16x16x32_f16 v[40:43], v[56:59], v[96:99], v[40:43]
    v_mfma_f32_16x16x32_f16 v[44:47], v[60:63], v[96:99], v[44:47]
    buffer_load_dwordx4 v3, s[60:63], s64 offen offset:1024 lds
    ds_read_b128 v[240:243], v8 offset:1600
    ds_read2_b32 v[60:61], v13 offset0:144 offset1:145
    ds_read2_b32 v[62:63], v13 offset0:146 offset1:147
    v_mfma_f32_16x16x32_f16 v[36:39], v[48:51], v[100:103], v[36:39]
    v_mfma_f32_16x16x32_f16 v[40:43], v[52:55], v[100:103], v[40:43]
    buffer_load_dwordx4 v4, s[60:63], s64 offen offset:2048 lds
    v_mfma_f32_16x16x32_f16 v[44:47], v[56:59], v[100:103], v[44:47]
    ds_read_b128 v[244:247], v8 offset:1088
    ds_read2_b32 v[56:57], v13 offset0:16 offset1:17
    ds_read2_b32 v[58:59], v13 offset0:18 offset1:19
    v_mfma_f32_16x16x32_f16 v[40:43], v[48:51], v[104:107], v[40:43]
    buffer_load_dwordx4 v5, s[60:63], s64 offen offset:3072 lds
    s_add_u32 s64, s64, 131072
    s_cmp_eq_u32 s64, s65
    s_cselect_b32 s64, s66, s64
    v_mfma_f32_16x16x32_f16 v[44:47], v[52:55], v[104:107], v[44:47]
    ds_read_b128 v[248:251], v8 offset:576
    ds_read2_b32 v[52:53], v12 offset0:144 offset1:145
    ds_read2_b32 v[54:55], v12 offset0:146 offset1:147
    v_mfma_f32_16x16x32_f16 v[44:47], v[48:51], v[108:111], v[44:47]
    s_waitcnt vmcnt(9)
    ds_read_b64_tr_b16 v[176:177], v6 offset:8192
    ds_read_b64_tr_b16 v[178:179], v6 offset:8704
    ds_read_b64_tr_b16 v[180:181], v7 offset:8192
    ds_read_b64_tr_b16 v[182:183], v7 offset:8704
    ds_read_b128 v[252:255], v8 offset:64
    ds_read2_b32 v[48:49], v12 offset0:16 offset1:17
    ds_read2_b32 v[50:51], v12 offset0:18 offset1:19
    v_mfma_f32_16x16x32_f16 v[44:47], v[76:79], v[112:115], v[44:47]
    v_mfma_f32_16x16x32_f16 v[40:43], v[72:75], v[112:115], v[40:43]
    ds_read_b64_tr_b16 v[184:185], v6 offset:10240
    ds_read_b64_tr_b16 v[186:187], v6 offset:10752
    ds_read_b64_tr_b16 v[188:189], v7 offset:10240
    ds_read_b64_tr_b16 v[190:191], v7 offset:10752
    v_mfma_f32_16x16x32_f16 v[36:39], v[68:71], v[112:115], v[36:39]
    s_waitcnt lgkmcnt(15)
    v_mfma_f32_16x16x32_f16 v[32:35], v[64:67], v[112:115], v[32:35]
    s_waitcnt lgkmcnt(0)
    s_add_u32 m0, s70, 8192
    s_nop 0
    buffer_load_dwordx4 v2, s[60:63], s64 offen offset:0 lds
    v_mfma_f32_16x16x32_f16 v[28:31], v[60:63], v[112:115], v[28:31]
    v_mfma_f32_16x16x32_f16 v[24:27], v[56:59], v[112:115], v[24:27]
    buffer_load_dwordx4 v3, s[60:63], s64 offen offset:1024 lds
    v_mfma_f32_16x16x32_f16 v[20:23], v[52:55], v[112:115], v[20:23]
    v_mfma_f32_16x16x32_f16 v[16:19], v[48:51], v[112:115], v[16:19]
    buffer_load_dwordx4 v4, s[60:63], s64 offen offset:2048 lds
    v_mfma_f32_16x16x32_f16 v[20:23], v[48:51], v[116:119], v[20:23]
    v_mfma_f32_16x16x32_f16 v[24:27], v[52:55], v[116:119], v[24:27]
    buffer_load_dwordx4 v5, s[60:63], s64 offen offset:3072 lds
    s_add_u32 s64, s64, 131072
    s_cmp_eq_u32 s64, s65
    s_cselect_b32 s64, s66, s64
    v_mfma_f32_16x16x32_f16 v[28:31], v[56:59], v[116:119], v[28:31]
    v_mfma_f32_16x16x32_f16 v[32:35], v[60:63], v[116:119], v[32:35]
    s_waitcnt vmcnt(8)
    ds_read_b64_tr_b16 v[192:193], v6 offset:12288
    ds_read_b64_tr_b16 v[194:195], v6 offset:12800
    ds_read_b64_tr_b16 v[196:197], v7 offset:12288
    ds_read_b64_tr_b16 v[198:199], v7 offset:12800
    v_mfma_f32_16x16x32_f16 v[36:39], v[64:67], v[116:119], v[36:39]
    v_mfma_f32_16x16x32_f16 v[40:43], v[68:71], v[116:119], v[40:43]
    ds_read_b64_tr_b16 v[200:201], v6 offset:14336
    ds_read_b64_tr_b16 v[202:203], v6 offset:14848
    ds_read_b64_tr_b16 v[204:205], v7 offset:14336
    ds_read_b64_tr_b16 v[206:207], v7 offset:14848
    v_mfma_f32_16x16x32_f16 v[44:47], v[72:75], v[116:119], v[44:47]
    v_mfma_f32_16x16x32_f16 v[24:27], v[48:51], v[120:123], v[24:27]
    v_mfma_f32_16x16x32_f16 v[28:31], v[52:55], v[120:123], v[28:31]
    v_mfma_f32_16x16x32_f16 v[32:35], v[56:59], v[120:123], v[32:35]
    v_mfma_f32_16x16x32_f16 v[36:39], v[60:63], v[120:123], v[36:39]
    v_mfma_f32_16x16x32_f16 v[40:43], v[64:67], v[120:123], v[40:43]
    v_mfma_f32_16x16x32_f16 v[44:47], v[68:71], v[120:123], v[44:47]
    v_mfma_f32_16x16x32_f16 v[28:31], v[48:51], v[124:127], v[28:31]
    v_mfma_f32_16x16x32_f16 v[32:35], v[52:55], v[124:127], v[32:35]
    v_mfma_f32_16x16x32_f16 v[36:39], v[56:59], v[124:127], v[36:39]
    s_waitcnt vmcnt(4)
    ds_read_b64_tr_b16 v[208:209], v6 offset:4096
    ds_read_b64_tr_b16 v[210:211], v6 offset:4608
    ds_read_b64_tr_b16 v[212:213], v7 offset:4096
    ds_read_b64_tr_b16 v[214:215], v7 offset:4608
    v_mfma_f32_16x16x32_f16 v[40:43], v[60:63], v[124:127], v[40:43]
    v_mfma_f32_16x16x32_f16 v[44:47], v[64:67], v[124:127], v[44:47]
    ds_read_b64_tr_b16 v[216:217], v6 offset:6144
    ds_read_b64_tr_b16 v[218:219], v6 offset:6656
    ds_read_b64_tr_b16 v[220:221], v7 offset:6144
    ds_read_b64_tr_b16 v[222:223], v7 offset:6656
    v_mfma_f32_16x16x32_f16 v[32:35], v[48:51], v[240:243], v[32:35]
    v_mfma_f32_16x16x32_f16 v[36:39], v[52:55], v[240:243], v[36:39]
    v_mfma_f32_16x16x32_f16 v[40:43], v[56:59], v[240:243], v[40:43]
    v_mfma_f32_16x16x32_f16 v[44:47], v[60:63], v[240:243], v[44:47]
    s_waitcnt vmcnt(0)
    ds_read_b64_tr_b16 v[224:225], v6 offset:8192
    ds_read_b64_tr_b16 v[226:227], v6 offset:8704
    ds_read_b64_tr_b16 v[228:229], v7 offset:8192
    ds_read_b64_tr_b16 v[230:231], v7 offset:8704
    v_mfma_f32_16x16x32_f16 v[36:39], v[48:51], v[244:247], v[36:39]
    v_mfma_f32_16x16x32_f16 v[40:43], v[52:55], v[244:247], v[40:43]
    buffer_load_dwordx4 v[80:83], v1, s[56:59], s67 offen offset:0
    buffer_load_dwordx4 v[84:87], v1, s[56:59], s68 offen offset:0
    buffer_load_dwordx4 v[88:91], v1, s[56:59], s67 offen offset:1024
    buffer_load_dwordx4 v[92:95], v1, s[56:59], s68 offen offset:1024
    s_add_u32 s67, s67, 2048
    s_cmp_eq_u32 s67, s69
    s_cselect_b32 s67, s74, s67
    s_add_u32 s68, s67, 114688
    buffer_load_dwordx4 v[96:99], v1, s[56:59], s67 offen offset:0
    buffer_load_dwordx4 v[100:103], v1, s[56:59], s68 offen offset:0
    buffer_load_dwordx4 v[104:107], v1, s[56:59], s67 offen offset:1024
    buffer_load_dwordx4 v[108:111], v1, s[56:59], s68 offen offset:1024
    s_add_u32 s67, s67, 2048
    s_cmp_eq_u32 s67, s69
    s_cselect_b32 s67, s74, s67
    s_add_u32 s68, s67, 114688
    ds_read_b64_tr_b16 v[232:233], v6 offset:10240
    ds_read_b64_tr_b16 v[234:235], v6 offset:10752
    ds_read_b64_tr_b16 v[236:237], v7 offset:10240
    ds_read_b64_tr_b16 v[238:239], v7 offset:10752
    v_mfma_f32_16x16x32_f16 v[44:47], v[56:59], v[244:247], v[44:47]
    v_mfma_f32_16x16x32_f16 v[40:43], v[48:51], v[248:251], v[40:43]
    v_mfma_f32_16x16x32_f16 v[44:47], v[52:55], v[248:251], v[44:47]
    v_mfma_f32_16x16x32_f16 v[44:47], v[48:51], v[252:255], v[44:47]
    s_waitcnt lgkmcnt(0)
    v_add_u32 v48, s70, v1
    ds_write_b128 v48, v[16:19] offset:8192
    ds_write_b128 v48, v[20:23] offset:9216
    ds_write_b128 v48, v[24:27] offset:10240
    ds_write_b128 v48, v[28:31] offset:11264
    ds_write_b128 v48, v[32:35] offset:12288
    ds_write_b128 v48, v[36:39] offset:13312
    ds_write_b128 v48, v[40:43] offset:14336
    ds_write_b128 v48, v[44:47] offset:15360
    s_lshl_b32 s12, s8, 16
    s_lshl_b32 s25, s14, 11
    s_add_u32 s12, s12, s25
    v_add_u32 v48, s12, v1
    v_and_b32 v49, 15, v0
    v_lshrrev_b32 v50, 4, v0
    v_lshlrev_b32 v49, 5, v49
    v_lshl_add_u32 v49, v50, 3, v49
    s_lshl_b32 s25, s14, 10
    s_add_u32 s12, s25, s21
    v_add_u32 v50, s12, v49
    ds_read_b64 v[52:53], v50 offset:32
    ds_read_b64 v[54:55], v50 offset:544
    s_lshl_b32 s12, s9, 12
    s_add_u32 s12, s12, s25
    s_add_u32 s28, s12, 0xa00000
    v_lshlrev_b32 v11, 16, v11
    s_waitcnt lgkmcnt(0)
    s_barrier
    ds_read_b128 v[16:19], v48 offset:8192
    ds_read_b128 v[20:23], v48 offset:9216
    ds_read_b128 v[24:27], v48 offset:24576
    ds_read_b128 v[28:31], v48 offset:25600
    ds_read_b128 v[32:35], v48 offset:40960
    ds_read_b128 v[36:39], v48 offset:41984
    ds_read_b128 v[40:43], v48 offset:57344
    ds_read_b128 v[44:47], v48 offset:58368
    v_fma_mix_f32 v56, v52, v11, 0 op_sel:[0,0,0] op_sel_hi:[1,0,0]
    v_fma_mix_f32 v57, v52, v11, 0 op_sel:[1,0,0] op_sel_hi:[1,0,0]
    v_fma_mix_f32 v58, v53, v11, 0 op_sel:[0,0,0] op_sel_hi:[1,0,0]
    v_fma_mix_f32 v59, v53, v11, 0 op_sel:[1,0,0] op_sel_hi:[1,0,0]
    v_fma_mix_f32 v60, v54, v11, 0 op_sel:[0,0,0] op_sel_hi:[1,0,0]
    v_fma_mix_f32 v61, v54, v11, 0 op_sel:[1,0,0] op_sel_hi:[1,0,0]
    v_fma_mix_f32 v62, v55, v11, 0 op_sel:[0,0,0] op_sel_hi:[1,0,0]
    v_fma_mix_f32 v63, v55, v11, 0 op_sel:[1,0,0] op_sel_hi:[1,0,0]
    v_cvt_pk_bf16_f32 v64, v56, v57
    v_cvt_pk_bf16_f32 v65, v58, v59
    v_cvt_pk_bf16_f32 v66, v60, v61
    v_cvt_pk_bf16_f32 v67, v62, v63
    v_lshlrev_b32 v56, 16, v64
    v_and_b32 v57, 0xffff0000, v64
    v_lshlrev_b32 v58, 16, v65
    v_and_b32 v59, 0xffff0000, v65
    v_lshlrev_b32 v60, 16, v66
    v_and_b32 v61, 0xffff0000, v66
    v_lshlrev_b32 v62, 16, v67
    v_and_b32 v63, 0xffff0000, v67
    s_waitcnt lgkmcnt(4)
    v_pk_add_f32 v[16:17], v[16:17], v[24:25]
    v_pk_add_f32 v[18:19], v[18:19], v[26:27]
    v_pk_add_f32 v[20:21], v[20:21], v[28:29]
    v_pk_add_f32 v[22:23], v[22:23], v[30:31]
    s_waitcnt lgkmcnt(0)
    v_pk_add_f32 v[32:33], v[32:33], v[40:41]
    v_pk_add_f32 v[34:35], v[34:35], v[42:43]
    v_pk_add_f32 v[36:37], v[36:37], v[44:45]
    v_pk_add_f32 v[38:39], v[38:39], v[46:47]
    v_pk_add_f32 v[16:17], v[16:17], v[32:33]
    v_pk_add_f32 v[18:19], v[18:19], v[34:35]
    v_pk_add_f32 v[20:21], v[20:21], v[36:37]
    v_pk_add_f32 v[22:23], v[22:23], v[38:39]
    v_ldexp_f32 v16, v16, -10
    v_ldexp_f32 v17, v17, -10
    v_ldexp_f32 v18, v18, -10
    v_ldexp_f32 v19, v19, -10
    v_ldexp_f32 v20, v20, -10
    v_ldexp_f32 v21, v21, -10
    v_ldexp_f32 v22, v22, -10
    v_ldexp_f32 v23, v23, -10
    v_cvt_pk_bf16_f32 v64, v16, v17
    v_cvt_pk_bf16_f32 v65, v18, v19
    v_cvt_pk_bf16_f32 v66, v20, v21
    v_cvt_pk_bf16_f32 v67, v22, v23
    v_lshlrev_b32 v16, 16, v64
    v_and_b32 v17, 0xffff0000, v64
    v_lshlrev_b32 v18, 16, v65
    v_and_b32 v19, 0xffff0000, v65
    v_lshlrev_b32 v20, 16, v66
    v_and_b32 v21, 0xffff0000, v66
    v_lshlrev_b32 v22, 16, v67
    v_and_b32 v23, 0xffff0000, v67
    v_pk_add_f32 v[16:17], v[16:17], v[56:57]
    v_pk_add_f32 v[18:19], v[18:19], v[58:59]
    v_pk_add_f32 v[20:21], v[20:21], v[60:61]
    v_pk_add_f32 v[22:23], v[22:23], v[62:63]
    v_cvt_pk_bf16_f32 v64, v16, v17
    v_cvt_pk_bf16_f32 v65, v18, v19
    v_cvt_pk_bf16_f32 v66, v20, v21
    v_cvt_pk_bf16_f32 v67, v22, v23
    buffer_store_dwordx2 v[64:65], v49, s[56:59], s28 offen sc1
    buffer_store_dwordx2 v[66:67], v49, s[56:59], s28 offen offset:512 sc1
    v_add_u32 v241, s70, v1
    ds_write_b128 v241, v[128:131] offset:0
    ds_write_b128 v241, v[132:135] offset:1024
    ds_write_b128 v241, v[136:139] offset:2048
    ds_write_b128 v241, v[140:143] offset:3072
    ds_read_b64_tr_b16 v[128:129], v6 offset:0
    ds_read_b64_tr_b16 v[130:131], v6 offset:512
    ds_read_b64_tr_b16 v[132:133], v7 offset:0
    ds_read_b64_tr_b16 v[134:135], v7 offset:512
    ds_read_b64_tr_b16 v[136:137], v6 offset:2048
    ds_read_b64_tr_b16 v[138:139], v6 offset:2560
    ds_read_b64_tr_b16 v[140:141], v7 offset:2048
    ds_read_b64_tr_b16 v[142:143], v7 offset:2560
    v_and_b32 v8, 31, v0
    v_lshrrev_b32 v9, 5, v0
    s_lshl_b32 s20, s75, 6
    s_lshl_b32 s12, s10, 5
    s_add_u32 s20, s20, s12
    s_lshl_b32 s21, s50, 6
    s_lshl_b32 s12, s8, 5
    s_add_u32 s21, s21, s12
    s_and_b32 s12, s3, 1
    s_lshl_b32 s12, s12, 4
    s_add_u32 s21, s21, s12
    s_lshl_b32 s12, s20, 1
    v_lshl_add_u32 v16, v8, 1, s12
    global_load_ushort v11, v16, s[42:43]
    s_lshl_b32 s22, s20, 10
    s_lshl_b32 s12, s21, 1
    s_add_u32 s22, s22, s12
    v_lshlrev_b32 v8, 10, v8
    v_lshl_add_u32 v8, v9, 4, v8
    buffer_load_dwordx4 v[12:15], v8, s[52:55], s22 offen
    s_waitcnt vmcnt(2)
    v_mov_b32 v16, 0
    v_mov_b32 v17, 1
    s_mov_b64 exec, 1
    buffer_store_dword v17, v16, s[56:59], s83 offen sc1
    s_mov_b64 exec, -1
    s_lshl_b32 s27, s50, 10
    s_lshr_b32 s12, s75, 3
    s_lshl_b32 s12, s12, 8
    s_add_u32 s27, s27, s12
    s_add_u32 s27, s27, 0xc02000
    v_lshlrev_b32 v10, 2, v0
    s_lshl_b32 s28, s21, 12
    s_lshl_b32 s12, s20, 1
    s_add_u32 s28, s28, s12
    s_add_u32 s28, s28, 0xa00000
    s_lshl_b32 s29, s3, 10
    s_add_u32 s29, s29, 131072
    v_lshrrev_b32 v2, 2, v0
    v_lshlrev_b32 v2, 12, v2
    v_and_b32 v3, 3, v0
    v_lshl_add_u32 v2, v3, 4, v2
    v_bfe_u32 v4, v0, 2, 2
    v_lshl_add_u32 v4, v9, 2, v4
    v_lshlrev_b32 v4, 6, v4
    v_bfe_u32 v5, v0, 4, 1
    v_lshl_add_u32 v4, v5, 5, v4
    v_lshl_add_u32 v4, v3, 3, v4
    v_add_u32 v4, s29, v4
    s_mov_b32 s60, s44
    s_mov_b32 s61, s45
    s_mov_b32 s62, 0x200000
    s_mov_b32 s63, 0x00020000
    s_barrier
    buffer_load_dwordx4 v[112:115], v1, s[56:59], s67 offen offset:0
    buffer_load_dwordx4 v[116:119], v1, s[56:59], s68 offen offset:0
    buffer_load_dwordx4 v[120:123], v1, s[56:59], s67 offen offset:1024
    buffer_load_dwordx4 v[124:127], v1, s[56:59], s68 offen offset:1024
    s_add_u32 s67, s67, 2048
    s_cmp_eq_u32 s67, s69
    s_cselect_b32 s67, s74, s67
    s_add_u32 s68, s67, 114688
    v_max3_u32 v16, v80, v81, v82
    v_max3_u32 v17, v83, v84, v85
    v_max3_u32 v16, v16, v86, v87
    v_max3_u32 v17, v17, v88, v89
    v_max3_u32 v16, v16, v90, v91
    v_max3_u32 v17, v17, v92, v93
    v_max3_u32 v16, v16, v94, v95
    v_max_u32 v16, v16, v17
    v_cmp_eq_u32 vcc, -1, v16
    s_cbranch_vccnz L_retry_28
L_chkok_29:
    s_waitcnt lgkmcnt(0)
    v_mfma_f32_32x32x16_bf16 v[16:31], v[80:83], v[128:131], 0
    ds_write_b128 v241, v[144:147] offset:0
    ds_write_b128 v241, v[148:151] offset:1024
    ds_write_b128 v241, v[152:155] offset:2048
    ds_write_b128 v241, v[156:159] offset:3072
    v_mfma_f32_32x32x16_bf16 v[32:47], v[80:83], v[132:135], 0
    v_mfma_f32_32x32x16_bf16 v[48:63], v[84:87], v[128:131], 0
    buffer_load_dwordx4 v[80:83], v1, s[56:59], s67 offen offset:0
    v_mfma_f32_32x32x16_bf16 v[64:79], v[84:87], v[132:135], 0
    ds_read_b64_tr_b16 v[144:145], v6 offset:0
    ds_read_b64_tr_b16 v[146:147], v6 offset:512
    ds_read_b64_tr_b16 v[148:149], v7 offset:0
    ds_read_b64_tr_b16 v[150:151], v7 offset:512
    v_mfma_f32_32x32x16_bf16 v[16:31], v[88:91], v[136:139], v[16:31]
    buffer_load_dwordx4 v[84:87], v1, s[56:59], s68 offen offset:0
    v_mfma_f32_32x32x16_bf16 v[32:47], v[88:91], v[140:143], v[32:47]
    ds_read_b64_tr_b16 v[152:153], v6 offset:2048
    ds_read_b64_tr_b16 v[154:155], v6 offset:2560
    ds_read_b64_tr_b16 v[156:157], v7 offset:2048
    ds_read_b64_tr_b16 v[158:159], v7 offset:2560
    v_mfma_f32_32x32x16_bf16 v[48:63], v[92:95], v[136:139], v[48:63]
    buffer_load_dwordx4 v[88:91], v1, s[56:59], s67 offen offset:1024
    v_mfma_f32_32x32x16_bf16 v[64:79], v[92:95], v[140:143], v[64:79]
    buffer_load_dwordx4 v[92:95], v1, s[56:59], s68 offen offset:1024
    s_add_u32 s67, s67, 2048
    s_cmp_eq_u32 s67, s69
    s_cselect_b32 s67, s74, s67
    s_add_u32 s68, s67, 114688
    v_max3_u32 v130, v96, v97, v98
    v_max3_u32 v131, v99, v100, v101
    v_max3_u32 v130, v130, v102, v103
    v_max3_u32 v131, v131, v104, v105
    v_max3_u32 v130, v130, v106, v107
    v_max3_u32 v131, v131, v108, v109
    v_max3_u32 v130, v130, v110, v111
    v_max_u32 v130, v130, v131
    v_cmp_eq_u32 vcc, -1, v130
    s_cbranch_vccnz L_retry_31
L_chkok_32:
    s_waitcnt lgkmcnt(0)
    v_mfma_f32_32x32x16_bf16 v[16:31], v[96:99], v[144:147], v[16:31]
    v_mfma_f32_32x32x16_bf16 v[32:47], v[96:99], v[148:151], v[32:47]
    v_mfma_f32_32x32x16_bf16 v[48:63], v[100:103], v[144:147], v[48:63]
    buffer_load_dwordx4 v[96:99], v1, s[56:59], s67 offen offset:0
    v_mfma_f32_32x32x16_bf16 v[64:79], v[100:103], v[148:151], v[64:79]
    v_mfma_f32_32x32x16_bf16 v[16:31], v[104:107], v[152:155], v[16:31]
    buffer_load_dwordx4 v[100:103], v1, s[56:59], s68 offen offset:0
    v_mfma_f32_32x32x16_bf16 v[32:47], v[104:107], v[156:159], v[32:47]
    v_mfma_f32_32x32x16_bf16 v[48:63], v[108:111], v[152:155], v[48:63]
    buffer_load_dwordx4 v[104:107], v1, s[56:59], s67 offen offset:1024
    v_mfma_f32_32x32x16_bf16 v[64:79], v[108:111], v[156:159], v[64:79]
    buffer_load_dwordx4 v[108:111], v1, s[56:59], s68 offen offset:1024
    s_add_u32 s67, s67, 2048
    s_cmp_eq_u32 s67, s69
    s_cselect_b32 s67, s74, s67
    s_add_u32 s68, s67, 114688
    s_waitcnt vmcnt(8)
    v_max3_u32 v146, v112, v113, v114
    v_max3_u32 v147, v115, v116, v117
    v_max3_u32 v146, v146, v118, v119
    v_max3_u32 v147, v147, v120, v121
    v_max3_u32 v146, v146, v122, v123
    v_max3_u32 v147, v147, v124, v125
    v_max3_u32 v146, v146, v126, v127
    v_max_u32 v146, v146, v147
    v_cmp_eq_u32 vcc, -1, v146
    s_cbranch_vccnz L_retry_34
L_chkok_35:
    v_mfma_f32_32x32x16_bf16 v[16:31], v[112:115], v[160:163], v[16:31]
    v_mfma_f32_32x32x16_bf16 v[32:47], v[112:115], v[164:167], v[32:47]
    v_mfma_f32_32x32x16_bf16 v[48:63], v[116:119], v[160:163], v[48:63]
    buffer_load_dwordx4 v[112:115], v1, s[56:59], s67 offen offset:0
    v_mfma_f32_32x32x16_bf16 v[64:79], v[116:119], v[164:167], v[64:79]
    v_mfma_f32_32x32x16_bf16 v[16:31], v[120:123], v[168:171], v[16:31]
    buffer_load_dwordx4 v[116:119], v1, s[56:59], s68 offen offset:0
    v_mfma_f32_32x32x16_bf16 v[32:47], v[120:123], v[172:175], v[32:47]
    v_mfma_f32_32x32x16_bf16 v[48:63], v[124:127], v[168:171], v[48:63]
    buffer_load_dwordx4 v[120:123], v1, s[56:59], s67 offen offset:1024
    v_mfma_f32_32x32x16_bf16 v[64:79], v[124:127], v[172:175], v[64:79]
    buffer_load_dwordx4 v[124:127], v1, s[56:59], s68 offen offset:1024
    s_add_u32 s67, s67, 2048
    s_cmp_eq_u32 s67, s69
    s_cselect_b32 s67, s74, s67
    s_add_u32 s68, s67, 114688
    s_waitcnt vmcnt(8)
    v_max3_u32 v162, v80, v81, v82
    v_max3_u32 v163, v83, v84, v85
    v_max3_u32 v162, v162, v86, v87
    v_max3_u32 v163, v163, v88, v89
    v_max3_u32 v162, v162, v90, v91
    v_max3_u32 v163, v163, v92, v93
    v_max3_u32 v162, v162, v94, v95
    v_max_u32 v162, v162, v163
    v_cmp_eq_u32 vcc, -1, v162
    s_cbranch_vccnz L_retry_37
L_chkok_38:
    v_mfma_f32_32x32x16_bf16 v[16:31], v[80:83], v[176:179], v[16:31]
    v_mfma_f32_32x32x16_bf16 v[32:47], v[80:83], v[180:183], v[32:47]
    v_mfma_f32_32x32x16_bf16 v[48:63], v[84:87], v[176:179], v[48:63]
    buffer_load_dwordx4 v[80:83], v1, s[56:59], s67 offen offset:0
    v_mfma_f32_32x32x16_bf16 v[64:79], v[84:87], v[180:183], v[64:79]
    v_mfma_f32_32x32x16_bf16 v[16:31], v[88:91], v[184:187], v[16:31]
    buffer_load_dwordx4 v[84:87], v1, s[56:59], s68 offen offset:0
    v_mfma_f32_32x32x16_bf16 v[32:47], v[88:91], v[188:191], v[32:47]
    v_mfma_f32_32x32x16_bf16 v[48:63], v[92:95], v[184:187], v[48:63]
    buffer_load_dwordx4 v[88:91], v1, s[56:59], s67 offen offset:1024
    v_mfma_f32_32x32x16_bf16 v[64:79], v[92:95], v[188:191], v[64:79]
    buffer_load_dwordx4 v[92:95], v1, s[56:59], s68 offen offset:1024
    s_add_u32 s67, s67, 2048
    s_cmp_eq_u32 s67, s69
    s_cselect_b32 s67, s74, s67
    s_add_u32 s68, s67, 114688
    s_waitcnt vmcnt(8)
    v_max3_u32 v178, v96, v97, v98
    v_max3_u32 v179, v99, v100, v101
    v_max3_u32 v178, v178, v102, v103
    v_max3_u32 v179, v179, v104, v105
    v_max3_u32 v178, v178, v106, v107
    v_max3_u32 v179, v179, v108, v109
    v_max3_u32 v178, v178, v110, v111
    v_max_u32 v178, v178, v179
    v_cmp_eq_u32 vcc, -1, v178
    s_cbranch_vccnz L_retry_40
L_chkok_41:
    v_mfma_f32_32x32x16_bf16 v[16:31], v[96:99], v[192:195], v[16:31]
    v_mfma_f32_32x32x16_bf16 v[32:47], v[96:99], v[196:199], v[32:47]
    v_mfma_f32_32x32x16_bf16 v[48:63], v[100:103], v[192:195], v[48:63]
    v_mfma_f32_32x32x16_bf16 v[64:79], v[100:103], v[196:199], v[64:79]
    v_mfma_f32_32x32x16_bf16 v[16:31], v[104:107], v[200:203], v[16:31]
    v_mfma_f32_32x32x16_bf16 v[32:47], v[104:107], v[204:207], v[32:47]
    v_mfma_f32_32x32x16_bf16 v[48:63], v[108:111], v[200:203], v[48:63]
    v_mfma_f32_32x32x16_bf16 v[64:79], v[108:111], v[204:207], v[64:79]
    buffer_load_dword v240, v10, s[56:59], s27 offen sc1
    s_waitcnt vmcnt(5)
    v_max3_u32 v194, v112, v113, v114
    v_max3_u32 v195, v115, v116, v117
    v_max3_u32 v194, v194, v118, v119
    v_max3_u32 v195, v195, v120, v121
    v_max3_u32 v194, v194, v122, v123
    v_max3_u32 v195, v195, v124, v125
    v_max3_u32 v194, v194, v126, v127
    v_max_u32 v194, v194, v195
    v_cmp_eq_u32 vcc, -1, v194
    s_cbranch_vccnz L_retry_43
L_chkok_44:
    v_mfma_f32_32x32x16_bf16 v[16:31], v[112:115], v[208:211], v[16:31]
    v_mfma_f32_32x32x16_bf16 v[32:47], v[112:115], v[212:215], v[32:47]
    v_mfma_f32_32x32x16_bf16 v[48:63], v[116:119], v[208:211], v[48:63]
    v_mfma_f32_32x32x16_bf16 v[64:79], v[116:119], v[212:215], v[64:79]
    v_mfma_f32_32x32x16_bf16 v[16:31], v[120:123], v[216:219], v[16:31]
    v_mfma_f32_32x32x16_bf16 v[32:47], v[120:123], v[220:223], v[32:47]
    v_mfma_f32_32x32x16_bf16 v[48:63], v[124:127], v[216:219], v[48:63]
    v_mfma_f32_32x32x16_bf16 v[64:79], v[124:127], v[220:223], v[64:79]
    s_waitcnt vmcnt(1)
    v_max3_u32 v210, v80, v81, v82
    v_max3_u32 v211, v83, v84, v85
    v_max3_u32 v210, v210, v86, v87
    v_max3_u32 v211, v211, v88, v89
    v_max3_u32 v210, v210, v90, v91
    v_max3_u32 v211, v211, v92, v93
    v_max3_u32 v210, v210, v94, v95
    v_max_u32 v210, v210, v211
    v_cmp_eq_u32 vcc, -1, v210
    s_cbranch_vccnz L_retry_46
L_chkok_47:
    v_mfma_f32_32x32x16_bf16 v[16:31], v[80:83], v[224:227], v[16:31]
    v_mfma_f32_32x32x16_bf16 v[32:47], v[80:83], v[228:231], v[32:47]
    v_mfma_f32_32x32x16_bf16 v[48:63], v[84:87], v[224:227], v[48:63]
    v_mfma_f32_32x32x16_bf16 v[64:79], v[84:87], v[228:231], v[64:79]
    v_mfma_f32_32x32x16_bf16 v[16:31], v[88:91], v[232:235], v[16:31]
    v_mfma_f32_32x32x16_bf16 v[32:47], v[88:91], v[236:239], v[32:47]
    v_mfma_f32_32x32x16_bf16 v[48:63], v[92:95], v[232:235], v[48:63]
    v_mfma_f32_32x32x16_bf16 v[64:79], v[92:95], v[236:239], v[64:79]
    s_waitcnt vmcnt(0)
    v_cmp_ne_u32 vcc, 1, v240
    s_cbranch_vccz L_p3ok_48
    s_mov_b32 s82, 0
L_spin_49:
    buffer_load_dword v240, v10, s[56:59], s27 offen sc1
    s_waitcnt vmcnt(0)
    v_cmp_ne_u32 vcc, 1, v240
    s_add_u32 s82, s82, 1
    s_cbranch_vccz L_spind_50
    s_cmp_ge_u32 s82, 65536
    s_cbranch_scc1 L_spind_50
    s_sleep 2
    s_branch L_spin_49
L_spind_50:
L_p3ok_48:
    s_mov_b32 m0, s29
    s_nop 0
    buffer_load_dwordx4 v2, s[56:59], s28 offen lds
    v_add_u32 v80, s70, v1
    ds_write_b128 v80, v[16:19] offset:0
    ds_write_b128 v80, v[20:23] offset:1024
    ds_write_b128 v80, v[24:27] offset:2048
    ds_write_b128 v80, v[28:31] offset:3072
    ds_write_b128 v80, v[32:35] offset:4096
    ds_write_b128 v80, v[36:39] offset:5120
    ds_write_b128 v80, v[40:43] offset:6144
    ds_write_b128 v80, v[44:47] offset:7168
    ds_write_b128 v80, v[48:51] offset:8192
    ds_write_b128 v80, v[52:55] offset:9216
    ds_write_b128 v80, v[56:59] offset:10240
    ds_write_b128 v80, v[60:63] offset:11264
    ds_write_b128 v80, v[64:67] offset:12288
    ds_write_b128 v80, v[68:71] offset:13312
    ds_write_b128 v80, v[72:75] offset:14336
    ds_write_b128 v80, v[76:79] offset:15360
    s_lshl_b32 s73, s3, 11
    v_add_u32 v80, s73, v1
    v_add_u32 v81, 0x10000, v80
    s_waitcnt lgkmcnt(0)
    s_barrier
    ds_read_b128 v[16:19], v80 offset:0
    ds_read_b128 v[20:23], v80 offset:1024
    ds_read_b128 v[24:27], v80 offset:16384
    ds_read_b128 v[28:31], v80 offset:17408
    ds_read_b128 v[32:35], v80 offset:32768
    ds_read_b128 v[36:39], v80 offset:33792
    ds_read_b128 v[40:43], v80 offset:49152
    ds_read_b128 v[44:47], v80 offset:50176
    ds_read_b128 v[48:51], v81 offset:0
    ds_read_b128 v[52:55], v81 offset:1024
    ds_read_b128 v[56:59], v81 offset:16384
    ds_read_b128 v[60:63], v81 offset:17408
    ds_read_b128 v[64:67], v81 offset:32768
    ds_read_b128 v[68:71], v81 offset:33792
    ds_read_b128 v[72:75], v81 offset:49152
    ds_read_b128 v[76:79], v81 offset:50176
    s_waitcnt vmcnt(0)
    ds_read_b64_tr_b16 v[84:85], v4
    ds_read_b64_tr_b16 v[86:87], v4 offset:512
    v_permlane32_swap_b32 v12, v14
    v_permlane32_swap_b32 v13, v15
    s_waitcnt lgkmcnt(14)
    v_pk_add_f32 v[16:17], v[16:17], v[24:25]
    v_pk_add_f32 v[18:19], v[18:19], v[26:27]
    v_pk_add_f32 v[20:21], v[20:21], v[28:29]
    v_pk_add_f32 v[22:23], v[22:23], v[30:31]
    s_waitcnt lgkmcnt(10)
    v_pk_add_f32 v[32:33], v[32:33], v[40:41]
    v_pk_add_f32 v[34:35], v[34:35], v[42:43]
    v_pk_add_f32 v[36:37], v[36:37], v[44:45]
    v_pk_add_f32 v[38:39], v[38:39], v[46:47]
    v_pk_add_f32 v[16:17], v[16:17], v[32:33]
    v_pk_add_f32 v[18:19], v[18:19], v[34:35]
    v_pk_add_f32 v[20:21], v[20:21], v[36:37]
    v_pk_add_f32 v[22:23], v[22:23], v[38:39]
    s_waitcnt lgkmcnt(6)
    v_pk_add_f32 v[48:49], v[48:49], v[56:57]
    v_pk_add_f32 v[50:51], v[50:51], v[58:59]
    v_pk_add_f32 v[52:53], v[52:53], v[60:61]
    v_pk_add_f32 v[54:55], v[54:55], v[62:63]
    s_waitcnt lgkmcnt(2)
    v_pk_add_f32 v[64:65], v[64:65], v[72:73]
    v_pk_add_f32 v[66:67], v[66:67], v[74:75]
    v_pk_add_f32 v[68:69], v[68:69], v[76:77]
    v_pk_add_f32 v[70:71], v[70:71], v[78:79]
    v_pk_add_f32 v[48:49], v[48:49], v[64:65]
    v_pk_add_f32 v[50:51], v[50:51], v[66:67]
    v_pk_add_f32 v[52:53], v[52:53], v[68:69]
    v_pk_add_f32 v[54:55], v[54:55], v[70:71]
    v_pk_add_f32 v[16:17], v[16:17], v[48:49]
    v_pk_add_f32 v[18:19], v[18:19], v[50:51]
    v_pk_add_f32 v[20:21], v[20:21], v[52:53]
    v_pk_add_f32 v[22:23], v[22:23], v[54:55]
    v_cvt_pk_bf16_f32 v24, v16, v17
    v_cvt_pk_bf16_f32 v25, v18, v19
    v_cvt_pk_bf16_f32 v26, v20, v21
    v_cvt_pk_bf16_f32 v27, v22, v23
    v_lshlrev_b32 v16, 16, v24
    v_and_b32 v17, 0xffff0000, v24
    v_lshlrev_b32 v18, 16, v25
    v_and_b32 v19, 0xffff0000, v25
    v_lshlrev_b32 v20, 16, v26
    v_and_b32 v21, 0xffff0000, v26
    v_lshlrev_b32 v22, 16, v27
    v_and_b32 v23, 0xffff0000, v27
    v_lshlrev_b32 v11, 16, v11
    v_add_f32 v16, v16, v11
    v_add_f32 v17, v17, v11
    v_add_f32 v18, v18, v11
    v_add_f32 v19, v19, v11
    v_add_f32 v20, v20, v11
    v_add_f32 v21, v21, v11
    v_add_f32 v22, v22, v11
    v_add_f32 v23, v23, v11
    v_cvt_pk_bf16_f32 v24, v16, v17
    v_cvt_pk_bf16_f32 v25, v18, v19
    v_cvt_pk_bf16_f32 v26, v20, v21
    v_cvt_pk_bf16_f32 v27, v22, v23
    v_lshlrev_b32 v16, 16, v24
    v_and_b32 v17, 0xffff0000, v24
    v_lshlrev_b32 v18, 16, v25
    v_and_b32 v19, 0xffff0000, v25
    v_lshlrev_b32 v20, 16, v26
    v_and_b32 v21, 0xffff0000, v26
    v_lshlrev_b32 v22, 16, v27
    v_and_b32 v23, 0xffff0000, v27
    s_mov_b32 s12, 0xbfb8aa3b
    v_mul_f32 v24, s12, v16
    v_mul_f32 v25, s12, v17
    v_mul_f32 v26, s12, v18
    v_mul_f32 v27, s12, v19
    v_mul_f32 v28, s12, v20
    v_mul_f32 v29, s12, v21
    v_mul_f32 v30, s12, v22
    v_mul_f32 v31, s12, v23
    v_exp_f32 v24, v24
    v_exp_f32 v25, v25
    v_exp_f32 v26, v26
    v_exp_f32 v27, v27
    v_exp_f32 v28, v28
    v_exp_f32 v29, v29
    v_exp_f32 v30, v30
    v_exp_f32 v31, v31
    v_add_f32 v24, 1.0, v24
    v_add_f32 v25, 1.0, v25
    v_add_f32 v26, 1.0, v26
    v_add_f32 v27, 1.0, v27
    v_add_f32 v28, 1.0, v28
    v_add_f32 v29, 1.0, v29
    v_add_f32 v30, 1.0, v30
    v_add_f32 v31, 1.0, v31
    v_rcp_f32 v24, v24
    v_rcp_f32 v25, v25
    v_rcp_f32 v26, v26
    v_rcp_f32 v27, v27
    v_rcp_f32 v28, v28
    v_rcp_f32 v29, v29
    v_rcp_f32 v30, v30
    v_rcp_f32 v31, v31
    v_pk_mul_f32 v[16:17], v[16:17], v[24:25]
    v_pk_mul_f32 v[18:19], v[18:19], v[26:27]
    v_pk_mul_f32 v[20:21], v[20:21], v[28:29]
    v_pk_mul_f32 v[22:23], v[22:23], v[30:31]
    v_cvt_pk_bf16_f32 v24, v16, v17
    v_cvt_pk_bf16_f32 v25, v18, v19
    v_cvt_pk_bf16_f32 v26, v20, v21
    v_cvt_pk_bf16_f32 v27, v22, v23
    v_lshlrev_b32 v16, 16, v24
    v_and_b32 v17, 0xffff0000, v24
    v_lshlrev_b32 v18, 16, v25
    v_and_b32 v19, 0xffff0000, v25
    v_lshlrev_b32 v20, 16, v26
    v_and_b32 v21, 0xffff0000, v26
    v_lshlrev_b32 v22, 16, v27
    v_and_b32 v23, 0xffff0000, v27
    s_waitcnt lgkmcnt(0)
    v_lshlrev_b32 v32, 16, v84
    v_and_b32 v33, 0xffff0000, v84
    v_lshlrev_b32 v34, 16, v85
    v_and_b32 v35, 0xffff0000, v85
    v_lshlrev_b32 v36, 16, v86
    v_and_b32 v37, 0xffff0000, v86
    v_lshlrev_b32 v38, 16, v87
    v_and_b32 v39, 0xffff0000, v87
    v_pk_mul_f32 v[16:17], v[16:17], v[32:33]
    v_pk_mul_f32 v[18:19], v[18:19], v[34:35]
    v_pk_mul_f32 v[20:21], v[20:21], v[36:37]
    v_pk_mul_f32 v[22:23], v[22:23], v[38:39]
    v_cvt_pk_bf16_f32 v24, v16, v17
    v_cvt_pk_bf16_f32 v25, v18, v19
    v_cvt_pk_bf16_f32 v26, v20, v21
    v_cvt_pk_bf16_f32 v27, v22, v23
    v_lshlrev_b32 v16, 16, v24
    v_and_b32 v17, 0xffff0000, v24
    v_lshlrev_b32 v18, 16, v25
    v_and_b32 v19, 0xffff0000, v25
    v_lshlrev_b32 v20, 16, v26
    v_and_b32 v21, 0xffff0000, v26
    v_lshlrev_b32 v22, 16, v27
    v_and_b32 v23, 0xffff0000, v27
    v_lshlrev_b32 v32, 16, v12
    v_and_b32 v33, 0xffff0000, v12
    v_lshlrev_b32 v34, 16, v13
    v_and_b32 v35, 0xffff0000, v13
    v_lshlrev_b32 v36, 16, v14
    v_and_b32 v37, 0xffff0000, v14
    v_lshlrev_b32 v38, 16, v15
    v_and_b32 v39, 0xffff0000, v15
    v_pk_add_f32 v[16:17], v[16:17], v[32:33]
    v_pk_add_f32 v[18:19], v[18:19], v[34:35]
    v_pk_add_f32 v[20:21], v[20:21], v[36:37]
    v_pk_add_f32 v[22:23], v[22:23], v[38:39]
    v_cvt_pk_bf16_f32 v24, v16, v17
    v_cvt_pk_bf16_f32 v25, v18, v19
    v_cvt_pk_bf16_f32 v26, v20, v21
    v_cvt_pk_bf16_f32 v27, v22, v23
    s_nop 0
    v_permlane32_swap_b32 v24, v26
    v_permlane32_swap_b32 v25, v27
    buffer_store_dwordx4 v[24:27], v8, s[60:63], s22 offen
    s_endpgm
L_end:
    s_endpgm
L_retry_28:
    s_mov_b32 s82, 0
L_chk_27:
    s_sleep 1
    s_add_u32 s73, s72, 0
    s_sub_u32 s12, s73, 7
    s_cmp_ge_u32 s73, 7
    s_cselect_b32 s73, s12, s73
    s_lshl_b32 s73, s73, 11
    s_add_u32 s73, s73, s74
    s_add_u32 s12, s73, 114688
    buffer_load_dwordx4 v[80:83], v1, s[56:59], s73 offen offset:0 sc1
    buffer_load_dwordx4 v[84:87], v1, s[56:59], s12 offen offset:0 sc1
    buffer_load_dwordx4 v[88:91], v1, s[56:59], s73 offen offset:1024 sc1
    buffer_load_dwordx4 v[92:95], v1, s[56:59], s12 offen offset:1024 sc1
    s_waitcnt vmcnt(0)
    v_max3_u32 v16, v80, v81, v82
    v_max3_u32 v17, v83, v84, v85
    v_max3_u32 v16, v16, v86, v87
    v_max3_u32 v17, v17, v88, v89
    v_max3_u32 v16, v16, v90, v91
    v_max3_u32 v17, v17, v92, v93
    v_max3_u32 v16, v16, v94, v95
    v_max_u32 v16, v16, v17
    v_cmp_eq_u32 vcc, -1, v16
    s_add_u32 s82, s82, 1
    s_cbranch_vccz L_retry_28_d
    s_cmp_lt_u32 s82, 65536
    s_cbranch_scc1 L_chk_27
L_retry_28_d:
    s_add_u32 s73, s72, 1
    s_sub_u32 s12, s73, 7
    s_cmp_ge_u32 s73, 7
    s_cselect_b32 s73, s12, s73
    s_lshl_b32 s73, s73, 11
    s_add_u32 s73, s73, s74
    s_add_u32 s12, s73, 114688
    buffer_load_dwordx4 v[96:99], v1, s[56:59], s73 offen offset:0 sc1
    buffer_load_dwordx4 v[100:103], v1, s[56:59], s12 offen offset:0 sc1
    buffer_load_dwordx4 v[104:107], v1, s[56:59], s73 offen offset:1024 sc1
    buffer_load_dwordx4 v[108:111], v1, s[56:59], s12 offen offset:1024 sc1
    s_add_u32 s73, s72, 2
    s_sub_u32 s12, s73, 7
    s_cmp_ge_u32 s73, 7
    s_cselect_b32 s73, s12, s73
    s_lshl_b32 s73, s73, 11
    s_add_u32 s73, s73, s74
    s_add_u32 s12, s73, 114688
    buffer_load_dwordx4 v[112:115], v1, s[56:59], s73 offen offset:0 sc1
    buffer_load_dwordx4 v[116:119], v1, s[56:59], s12 offen offset:0 sc1
    buffer_load_dwordx4 v[120:123], v1, s[56:59], s73 offen offset:1024 sc1
    buffer_load_dwordx4 v[124:127], v1, s[56:59], s12 offen offset:1024 sc1
    s_waitcnt vmcnt(0)
    s_branch L_chkok_29
L_retry_31:
    s_mov_b32 s82, 0
L_chk_30:
    s_sleep 1
    s_add_u32 s73, s72, 1
    s_sub_u32 s12, s73, 7
    s_cmp_ge_u32 s73, 7
    s_cselect_b32 s73, s12, s73
    s_lshl_b32 s73, s73, 11
    s_add_u32 s73, s73, s74
    s_add_u32 s12, s73, 114688
    buffer_load_dwordx4 v[96:99], v1, s[56:59], s73 offen offset:0 sc1
    buffer_load_dwordx4 v[100:103], v1, s[56:59], s12 offen offset:0 sc1
    buffer_load_dwordx4 v[104:107], v1, s[56:59], s73 offen offset:1024 sc1
    buffer_load_dwordx4 v[108:111], v1, s[56:59], s12 offen offset:1024 sc1
    s_waitcnt vmcnt(0)
    v_max3_u32 v130, v96, v97, v98
    v_max3_u32 v131, v99, v100, v101
    v_max3_u32 v130, v130, v102, v103
    v_max3_u32 v131, v131, v104, v105
    v_max3_u32 v130, v130, v106, v107
    v_max3_u32 v131, v131, v108, v109
    v_max3_u32 v130, v130, v110, v111
    v_max_u32 v130, v130, v131
    v_cmp_eq_u32 vcc, -1, v130
    s_add_u32 s82, s82, 1
    s_cbranch_vccz L_retry_31_d
    s_cmp_lt_u32 s82, 65536
    s_cbranch_scc1 L_chk_30
L_retry_31_d:
    s_add_u32 s73, s72, 2
    s_sub_u32 s12, s73, 7
    s_cmp_ge_u32 s73, 7
    s_cselect_b32 s73, s12, s73
    s_lshl_b32 s73, s73, 11
    s_add_u32 s73, s73, s74
    s_add_u32 s12, s73, 114688
    buffer_load_dwordx4 v[112:115], v1, s[56:59], s73 offen offset:0 sc1
    buffer_load_dwordx4 v[116:119], v1, s[56:59], s12 offen offset:0 sc1
    buffer_load_dwordx4 v[120:123], v1, s[56:59], s73 offen offset:1024 sc1
    buffer_load_dwordx4 v[124:127], v1, s[56:59], s12 offen offset:1024 sc1
    s_add_u32 s73, s72, 3
    s_sub_u32 s12, s73, 7
    s_cmp_ge_u32 s73, 7
    s_cselect_b32 s73, s12, s73
    s_lshl_b32 s73, s73, 11
    s_add_u32 s73, s73, s74
    s_add_u32 s12, s73, 114688
    buffer_load_dwordx4 v[80:83], v1, s[56:59], s73 offen offset:0 sc1
    buffer_load_dwordx4 v[84:87], v1, s[56:59], s12 offen offset:0 sc1
    buffer_load_dwordx4 v[88:91], v1, s[56:59], s73 offen offset:1024 sc1
    buffer_load_dwordx4 v[92:95], v1, s[56:59], s12 offen offset:1024 sc1
    s_waitcnt vmcnt(0)
    s_branch L_chkok_32
L_retry_34:
    s_mov_b32 s82, 0
L_chk_33:
    s_sleep 1
    s_add_u32 s73, s72, 2
    s_sub_u32 s12, s73, 7
    s_cmp_ge_u32 s73, 7
    s_cselect_b32 s73, s12, s73
    s_lshl_b32 s73, s73, 11
    s_add_u32 s73, s73, s74
    s_add_u32 s12, s73, 114688
    buffer_load_dwordx4 v[112:115], v1, s[56:59], s73 offen offset:0 sc1
    buffer_load_dwordx4 v[116:119], v1, s[56:59], s12 offen offset:0 sc1
    buffer_load_dwordx4 v[120:123], v1, s[56:59], s73 offen offset:1024 sc1
    buffer_load_dwordx4 v[124:127], v1, s[56:59], s12 offen offset:1024 sc1
    s_waitcnt vmcnt(0)
    v_max3_u32 v146, v112, v113, v114
    v_max3_u32 v147, v115, v116, v117
    v_max3_u32 v146, v146, v118, v119
    v_max3_u32 v147, v147, v120, v121
    v_max3_u32 v146, v146, v122, v123
    v_max3_u32 v147, v147, v124, v125
    v_max3_u32 v146, v146, v126, v127
    v_max_u32 v146, v146, v147
    v_cmp_eq_u32 vcc, -1, v146
    s_add_u32 s82, s82, 1
    s_cbranch_vccz L_retry_34_d
    s_cmp_lt_u32 s82, 65536
    s_cbranch_scc1 L_chk_33
L_retry_34_d:
    s_add_u32 s73, s72, 3
    s_sub_u32 s12, s73, 7
    s_cmp_ge_u32 s73, 7
    s_cselect_b32 s73, s12, s73
    s_lshl_b32 s73, s73, 11
    s_add_u32 s73, s73, s74
    s_add_u32 s12, s73, 114688
    buffer_load_dwordx4 v[80:83], v1, s[56:59], s73 offen offset:0 sc1
    buffer_load_dwordx4 v[84:87], v1, s[56:59], s12 offen offset:0 sc1
    buffer_load_dwordx4 v[88:91], v1, s[56:59], s73 offen offset:1024 sc1
    buffer_load_dwordx4 v[92:95], v1, s[56:59], s12 offen offset:1024 sc1
    s_add_u32 s73, s72, 4
    s_sub_u32 s12, s73, 7
    s_cmp_ge_u32 s73, 7
    s_cselect_b32 s73, s12, s73
    s_lshl_b32 s73, s73, 11
    s_add_u32 s73, s73, s74
    s_add_u32 s12, s73, 114688
    buffer_load_dwordx4 v[96:99], v1, s[56:59], s73 offen offset:0 sc1
    buffer_load_dwordx4 v[100:103], v1, s[56:59], s12 offen offset:0 sc1
    buffer_load_dwordx4 v[104:107], v1, s[56:59], s73 offen offset:1024 sc1
    buffer_load_dwordx4 v[108:111], v1, s[56:59], s12 offen offset:1024 sc1
    s_waitcnt vmcnt(0)
    s_branch L_chkok_35
L_retry_37:
    s_mov_b32 s82, 0
L_chk_36:
    s_sleep 1
    s_add_u32 s73, s72, 3
    s_sub_u32 s12, s73, 7
    s_cmp_ge_u32 s73, 7
    s_cselect_b32 s73, s12, s73
    s_lshl_b32 s73, s73, 11
    s_add_u32 s73, s73, s74
    s_add_u32 s12, s73, 114688
    buffer_load_dwordx4 v[80:83], v1, s[56:59], s73 offen offset:0 sc1
    buffer_load_dwordx4 v[84:87], v1, s[56:59], s12 offen offset:0 sc1
    buffer_load_dwordx4 v[88:91], v1, s[56:59], s73 offen offset:1024 sc1
    buffer_load_dwordx4 v[92:95], v1, s[56:59], s12 offen offset:1024 sc1
    s_waitcnt vmcnt(0)
    v_max3_u32 v162, v80, v81, v82
    v_max3_u32 v163, v83, v84, v85
    v_max3_u32 v162, v162, v86, v87
    v_max3_u32 v163, v163, v88, v89
    v_max3_u32 v162, v162, v90, v91
    v_max3_u32 v163, v163, v92, v93
    v_max3_u32 v162, v162, v94, v95
    v_max_u32 v162, v162, v163
    v_cmp_eq_u32 vcc, -1, v162
    s_add_u32 s82, s82, 1
    s_cbranch_vccz L_retry_37_d
    s_cmp_lt_u32 s82, 65536
    s_cbranch_scc1 L_chk_36
L_retry_37_d:
    s_add_u32 s73, s72, 4
    s_sub_u32 s12, s73, 7
    s_cmp_ge_u32 s73, 7
    s_cselect_b32 s73, s12, s73
    s_lshl_b32 s73, s73, 11
    s_add_u32 s73, s73, s74
    s_add_u32 s12, s73, 114688
    buffer_load_dwordx4 v[96:99], v1, s[56:59], s73 offen offset:0 sc1
    buffer_load_dwordx4 v[100:103], v1, s[56:59], s12 offen offset:0 sc1
    buffer_load_dwordx4 v[104:107], v1, s[56:59], s73 offen offset:1024 sc1
    buffer_load_dwordx4 v[108:111], v1, s[56:59], s12 offen offset:1024 sc1
    s_add_u32 s73, s72, 5
    s_sub_u32 s12, s73, 7
    s_cmp_ge_u32 s73, 7
    s_cselect_b32 s73, s12, s73
    s_lshl_b32 s73, s73, 11
    s_add_u32 s73, s73, s74
    s_add_u32 s12, s73, 114688
    buffer_load_dwordx4 v[112:115], v1, s[56:59], s73 offen offset:0 sc1
    buffer_load_dwordx4 v[116:119], v1, s[56:59], s12 offen offset:0 sc1
    buffer_load_dwordx4 v[120:123], v1, s[56:59], s73 offen offset:1024 sc1
    buffer_load_dwordx4 v[124:127], v1, s[56:59], s12 offen offset:1024 sc1
    s_waitcnt vmcnt(0)
    s_branch L_chkok_38
L_retry_40:
    s_mov_b32 s82, 0
L_chk_39:
    s_sleep 1
    s_add_u32 s73, s72, 4
    s_sub_u32 s12, s73, 7
    s_cmp_ge_u32 s73, 7
    s_cselect_b32 s73, s12, s73
    s_lshl_b32 s73, s73, 11
    s_add_u32 s73, s73, s74
    s_add_u32 s12, s73, 114688
    buffer_load_dwordx4 v[96:99], v1, s[56:59], s73 offen offset:0 sc1
    buffer_load_dwordx4 v[100:103], v1, s[56:59], s12 offen offset:0 sc1
    buffer_load_dwordx4 v[104:107], v1, s[56:59], s73 offen offset:1024 sc1
    buffer_load_dwordx4 v[108:111], v1, s[56:59], s12 offen offset:1024 sc1
    s_waitcnt vmcnt(0)
    v_max3_u32 v178, v96, v97, v98
    v_max3_u32 v179, v99, v100, v101
    v_max3_u32 v178, v178, v102, v103
    v_max3_u32 v179, v179, v104, v105
    v_max3_u32 v178, v178, v106, v107
    v_max3_u32 v179, v179, v108, v109
    v_max3_u32 v178, v178, v110, v111
    v_max_u32 v178, v178, v179
    v_cmp_eq_u32 vcc, -1, v178
    s_add_u32 s82, s82, 1
    s_cbranch_vccz L_retry_40_d
    s_cmp_lt_u32 s82, 65536
    s_cbranch_scc1 L_chk_39
L_retry_40_d:
    s_add_u32 s73, s72, 5
    s_sub_u32 s12, s73, 7
    s_cmp_ge_u32 s73, 7
    s_cselect_b32 s73, s12, s73
    s_lshl_b32 s73, s73, 11
    s_add_u32 s73, s73, s74
    s_add_u32 s12, s73, 114688
    buffer_load_dwordx4 v[112:115], v1, s[56:59], s73 offen offset:0 sc1
    buffer_load_dwordx4 v[116:119], v1, s[56:59], s12 offen offset:0 sc1
    buffer_load_dwordx4 v[120:123], v1, s[56:59], s73 offen offset:1024 sc1
    buffer_load_dwordx4 v[124:127], v1, s[56:59], s12 offen offset:1024 sc1
    s_add_u32 s73, s72, 6
    s_sub_u32 s12, s73, 7
    s_cmp_ge_u32 s73, 7
    s_cselect_b32 s73, s12, s73
    s_lshl_b32 s73, s73, 11
    s_add_u32 s73, s73, s74
    s_add_u32 s12, s73, 114688
    buffer_load_dwordx4 v[80:83], v1, s[56:59], s73 offen offset:0 sc1
    buffer_load_dwordx4 v[84:87], v1, s[56:59], s12 offen offset:0 sc1
    buffer_load_dwordx4 v[88:91], v1, s[56:59], s73 offen offset:1024 sc1
    buffer_load_dwordx4 v[92:95], v1, s[56:59], s12 offen offset:1024 sc1
    s_waitcnt vmcnt(0)
    s_branch L_chkok_41
L_retry_43:
    s_mov_b32 s82, 0
L_chk_42:
    s_sleep 1
    s_add_u32 s73, s72, 5
    s_sub_u32 s12, s73, 7
    s_cmp_ge_u32 s73, 7
    s_cselect_b32 s73, s12, s73
    s_lshl_b32 s73, s73, 11
    s_add_u32 s73, s73, s74
    s_add_u32 s12, s73, 114688
    buffer_load_dwordx4 v[112:115], v1, s[56:59], s73 offen offset:0 sc1
    buffer_load_dwordx4 v[116:119], v1, s[56:59], s12 offen offset:0 sc1
    buffer_load_dwordx4 v[120:123], v1, s[56:59], s73 offen offset:1024 sc1
    buffer_load_dwordx4 v[124:127], v1, s[56:59], s12 offen offset:1024 sc1
    s_waitcnt vmcnt(0)
    v_max3_u32 v194, v112, v113, v114
    v_max3_u32 v195, v115, v116, v117
    v_max3_u32 v194, v194, v118, v119
    v_max3_u32 v195, v195, v120, v121
    v_max3_u32 v194, v194, v122, v123
    v_max3_u32 v195, v195, v124, v125
    v_max3_u32 v194, v194, v126, v127
    v_max_u32 v194, v194, v195
    v_cmp_eq_u32 vcc, -1, v194
    s_add_u32 s82, s82, 1
    s_cbranch_vccz L_retry_43_d
    s_cmp_lt_u32 s82, 65536
    s_cbranch_scc1 L_chk_42
L_retry_43_d:
    s_add_u32 s73, s72, 6
    s_sub_u32 s12, s73, 7
    s_cmp_ge_u32 s73, 7
    s_cselect_b32 s73, s12, s73
    s_lshl_b32 s73, s73, 11
    s_add_u32 s73, s73, s74
    s_add_u32 s12, s73, 114688
    buffer_load_dwordx4 v[80:83], v1, s[56:59], s73 offen offset:0 sc1
    buffer_load_dwordx4 v[84:87], v1, s[56:59], s12 offen offset:0 sc1
    buffer_load_dwordx4 v[88:91], v1, s[56:59], s73 offen offset:1024 sc1
    buffer_load_dwordx4 v[92:95], v1, s[56:59], s12 offen offset:1024 sc1
    s_waitcnt vmcnt(0)
    s_branch L_chkok_44
L_retry_46:
    s_mov_b32 s82, 0
L_chk_45:
    s_sleep 1
    s_add_u32 s73, s72, 6
    s_sub_u32 s12, s73, 7
    s_cmp_ge_u32 s73, 7
    s_cselect_b32 s73, s12, s73
    s_lshl_b32 s73, s73, 11
    s_add_u32 s73, s73, s74
    s_add_u32 s12, s73, 114688
    buffer_load_dwordx4 v[80:83], v1, s[56:59], s73 offen offset:0 sc1
    buffer_load_dwordx4 v[84:87], v1, s[56:59], s12 offen offset:0 sc1
    buffer_load_dwordx4 v[88:91], v1, s[56:59], s73 offen offset:1024 sc1
    buffer_load_dwordx4 v[92:95], v1, s[56:59], s12 offen offset:1024 sc1
    s_waitcnt vmcnt(0)
    v_max3_u32 v210, v80, v81, v82
    v_max3_u32 v211, v83, v84, v85
    v_max3_u32 v210, v210, v86, v87
    v_max3_u32 v211, v211, v88, v89
    v_max3_u32 v210, v210, v90, v91
    v_max3_u32 v211, v211, v92, v93
    v_max3_u32 v210, v210, v94, v95
    v_max_u32 v210, v210, v211
    v_cmp_eq_u32 vcc, -1, v210
    s_add_u32 s82, s82, 1
    s_cbranch_vccz L_retry_46_d
    s_cmp_lt_u32 s82, 65536
    s_cbranch_scc1 L_chk_45
L_retry_46_d:
    s_waitcnt vmcnt(0)
    s_branch L_chkok_47
.section .rodata,"a"
.p2align 6
.amdhsa_kernel recurrent_scan__ssm_conv_s4__mixer_token_mlp__prompt_kernel
  .amdhsa_next_free_vgpr 256
  .amdhsa_next_free_sgpr 102
  .amdhsa_accum_offset 256
  .amdhsa_group_segment_fixed_size 0
  .amdhsa_kernarg_size 136
  .amdhsa_user_sgpr_count 2
  .amdhsa_user_sgpr_kernarg_segment_ptr 1
  .amdhsa_system_sgpr_workgroup_id_x 1
.end_amdhsa_kernel
```
